```python
import torch

def _softmax(x, axis=-1):
    return torch.softmax(x, dim=axis)
def _gelu(x):
    return torch.nn.functional.gelu(x, approximate="tanh")
def _silu(x):
    return torch.nn.functional.silu(x)
def _sigmoid(x):
    return torch.sigmoid(x)
def _layernorm(x, axis=-1, eps=1e-5):
    m = x.mean(dim=axis, keepdim=True)
    v = x.var(dim=axis, keepdim=True, unbiased=False)
    return (x - m) / torch.sqrt(v + eps)
def _scatter_add(tgt, idx, src, axis=0):
    return tgt.clone().index_add_(axis, idx, src)
def _segment_sum(src, seg, n):
    out = torch.zeros((n,) + src.shape[1:], dtype=src.dtype)
    return out.index_add_(0, seg, src)
def _pad(x, pw):
    flat = tuple(v for pair in reversed(pw) for v in pair)
    return torch.nn.functional.pad(x, flat)

kernel_name = 'standalone__sliding_block_cached__decode'

def setup_inputs():

    _w = (lambda a: (lambda t: t.to(torch.bfloat16) if t.is_floating_point() else t)(torch.as_tensor(a)))
    B, Sq, D = 1, 1, 640
    Hq, Hkv, Sk, Dh = 32, 32, 4096, 192
    assert Hq % Hkv == 0, (Hq, Hkv)
    return {
        "x": _w((lambda *s: torch.randn(*s, dtype=torch.bfloat16) * 1.6)(B, Sq, D)),
        "k_cache": _w((lambda *s: torch.randn(*s, dtype=torch.bfloat16) * 1.6)(B, Hkv, Sk, Dh)),
        "v_cache": _w((lambda *s: torch.randn(*s, dtype=torch.bfloat16) * 0.05)(B, Hkv, Sk, Dh)),
        "wq": _w((lambda *s: torch.randn(*s, dtype=torch.bfloat16) * 1.6)(D, Hq * Dh) * (D ** -0.5)),
        "wo": _w((lambda *s: torch.randn(*s, dtype=torch.bfloat16) * 0.05)(Hq * Dh, D) * ((Hq * Dh) ** -0.5)),
    }

def reference(x, k_cache, v_cache, wq, wo):
    B, Sq, D = x.shape
    Hq, Dh = 32, 192
    Hkv, Sk = k_cache.shape[1], k_cache.shape[2]
    W = min(4096, max(256, Sk // 4))
    rep = Hq // Hkv
    q = (lambda x, *d: x.permute(*d))((x @ wq).reshape(B, Sq, Hq, Dh), 0, 2, 1, 3)
    k = (lambda x, n, axis: torch.repeat_interleave(x, n, dim=axis))(k_cache[:, :, Sk - W:, :], rep, axis=1)
    v = (lambda x, n, axis: torch.repeat_interleave(x, n, dim=axis))(v_cache[:, :, Sk - W:, :], rep, axis=1)
    scores = torch.einsum("bhqd,bhkd->bhqk", q, k) * (Dh ** -0.5)
    p = _softmax(scores, axis=-1)
    o = torch.einsum("bhqk,bhkd->bhqd", p, v)
    return (lambda x, *d: x.permute(*d))(o, 0, 2, 1, 3).reshape(B, Sq, Hq * Dh) @ wo
```

```asm
; @launch grid=(256,1,1) block=(1024,1,1) lds=75776
.amdgcn_target "amdgcn-amd-amdhsa--gfx950"
.text
.globl standalone__sliding_block_cached__decode_kernel
.p2align 8
.type standalone__sliding_block_cached__decode_kernel,@function
standalone__sliding_block_cached__decode_kernel:
    s_cmp_ge_u32 s2, 256
    s_cbranch_scc1 L_end
    s_load_dwordx16 s[4:19], s[0:1], 0
    s_memrealtime s[70:71]
    v_lshrrev_b32 v1, 6, v0
    v_and_b32 v0, 63, v0
    s_and_b32 s48, s2, 31
    s_lshr_b32 s49, s2, 5
    v_readfirstlane_b32 s50, v1
    s_waitcnt lgkmcnt(0)
    s_mov_b32 s20, s6
    s_and_b32 s21, s7, 0xffff
    s_mov_b32 s22, 50331648
    s_mov_b32 s23, 0x00020000
    s_mov_b32 s24, s8
    s_and_b32 s25, s9, 0xffff
    s_mov_b32 s26, 50331648
    s_mov_b32 s27, 0x00020000
    s_mov_b32 s28, s10
    s_and_b32 s29, s11, 0xffff
    s_mov_b32 s30, 7864320
    s_mov_b32 s31, 0x00020000
    s_mov_b32 s32, s12
    s_and_b32 s33, s13, 0xffff
    s_mov_b32 s34, 7864320
    s_mov_b32 s35, 0x00020000
    s_mov_b32 s36, s14
    s_and_b32 s37, s15, 0xffff
    s_mov_b32 s38, 1280
    s_mov_b32 s39, 0x00020000
    s_mov_b32 s40, s16
    s_and_b32 s41, s17, 0xffff
    s_mov_b32 s42, 256
    s_mov_b32 s43, 0x00020000
    s_mov_b32 s44, s18
    s_and_b32 s45, s19, 0xffff
    s_mov_b32 s46, 4194304
    s_mov_b32 s47, 0x00020000
    s_and_b32 s51, s50, 3
    s_cmp_ge_u32 s50, 12
    s_cbranch_scc1 L_wrole
    s_cmp_ge_u32 s50, 8
    s_cbranch_scc1 L_vrole
    s_cmp_ge_u32 s50, 4
    s_cbranch_scc1 L_krole
    s_cmp_lg_u32 s51, 0
    s_cbranch_scc1 L_q_nononce
    s_or_b32 s70, s70, 1
    v_mov_b32 v12, s70
    v_mov_b32 v13, 0
    s_lshl_b32 s71, s48, 2
    s_add_u32 s71, s71, 128
    v_mov_b32 v14, s71
    v_mov_b32 v2, 0
    v_lshlrev_b32 v3, 2, v0
    s_mov_b64 exec, 1
    buffer_atomic_cmpswap v[12:13], v14, s[40:43], 0 offen sc0 sc1
    s_mov_b64 exec, 0xffff
    ds_write_b32 v3, v2 offset:6688
    s_mov_b64 exec, -1
L_q_nononce:
    s_mul_i32 s52, s49, 160
    s_mul_i32 s53, s51, 40
    s_add_u32 s52, s52, s53
    s_add_u32 s54, s4, s52
    s_addc_u32 s55, s5, 0
    s_load_dwordx8 s[56:63], s[54:55], 0
    s_load_dwordx2 s[64:65], s[54:55], 32
    v_and_b32 v1, 31, v0
    v_lshrrev_b32 v9, 5, v0
    v_mul_u32_u24 v1, 12, v1
    v_mul_u32_u24 v3, 0x3000, v9
    v_add_u32 v1, v1, v3
    s_mul_i32 s52, s49, 80
    s_mul_i32 s53, s51, 20
    s_add_u32 s52, s52, s53
    s_mul_i32 s52, s52, 12288
    s_mul_i32 s53, s48, 384
    s_add_u32 s52, s52, s53
    buffer_load_dwordx3 v[16:18], v1, s[28:31], s52 offen nt
    s_add_u32 s52, s52, 24576
    buffer_load_dwordx3 v[20:22], v1, s[28:31], s52 offen nt
    s_add_u32 s52, s52, 24576
    buffer_load_dwordx3 v[24:26], v1, s[28:31], s52 offen nt
    s_add_u32 s52, s52, 24576
    buffer_load_dwordx3 v[28:30], v1, s[28:31], s52 offen nt
    s_add_u32 s52, s52, 24576
    buffer_load_dwordx3 v[32:34], v1, s[28:31], s52 offen nt
    s_add_u32 s52, s52, 24576
    buffer_load_dwordx3 v[36:38], v1, s[28:31], s52 offen nt
    s_add_u32 s52, s52, 24576
    buffer_load_dwordx3 v[40:42], v1, s[28:31], s52 offen nt
    s_add_u32 s52, s52, 24576
    buffer_load_dwordx3 v[44:46], v1, s[28:31], s52 offen nt
    s_add_u32 s52, s52, 24576
    buffer_load_dwordx3 v[48:50], v1, s[28:31], s52 offen nt
    s_add_u32 s52, s52, 24576
    buffer_load_dwordx3 v[52:54], v1, s[28:31], s52 offen nt
    s_waitcnt lgkmcnt(0)
    s_barrier
    v_cmp_gt_u32 vcc, 32, v0
    v_mov_b32 v11, 0
    v_mov_b32 v2, 0
    v_cndmask_b32 v9, v11, 16, vcc
    v_mov_b32 v3, 0
    v_mov_b32 v4, 0
    v_mov_b32 v5, 0
    v_mov_b32 v6, 0
    v_mov_b32 v7, 0
    s_waitcnt lgkmcnt(0)
    s_waitcnt vmcnt(9)
    v_lshlrev_b32_e64 v8, v9, s56
    v_and_b32 v8, 0xffff0000, v8
    v_lshlrev_b32 v10, 16, v16
    v_and_b32 v11, 0xffff0000, v16
    v_fmac_f32 v2, v8, v10
    v_fmac_f32 v3, v8, v11
    v_lshlrev_b32 v10, 16, v17
    v_and_b32 v11, 0xffff0000, v17
    v_fmac_f32 v4, v8, v10
    v_fmac_f32 v5, v8, v11
    v_lshlrev_b32 v10, 16, v18
    v_and_b32 v11, 0xffff0000, v18
    v_fmac_f32 v6, v8, v10
    v_fmac_f32 v7, v8, v11
    s_waitcnt vmcnt(8)
    v_lshlrev_b32_e64 v8, v9, s57
    v_and_b32 v8, 0xffff0000, v8
    v_lshlrev_b32 v10, 16, v20
    v_and_b32 v11, 0xffff0000, v20
    v_fmac_f32 v2, v8, v10
    v_fmac_f32 v3, v8, v11
    v_lshlrev_b32 v10, 16, v21
    v_and_b32 v11, 0xffff0000, v21
    v_fmac_f32 v4, v8, v10
    v_fmac_f32 v5, v8, v11
    v_lshlrev_b32 v10, 16, v22
    v_and_b32 v11, 0xffff0000, v22
    v_fmac_f32 v6, v8, v10
    v_fmac_f32 v7, v8, v11
    s_waitcnt vmcnt(7)
    v_lshlrev_b32_e64 v8, v9, s58
    v_and_b32 v8, 0xffff0000, v8
    v_lshlrev_b32 v10, 16, v24
    v_and_b32 v11, 0xffff0000, v24
    v_fmac_f32 v2, v8, v10
    v_fmac_f32 v3, v8, v11
    v_lshlrev_b32 v10, 16, v25
    v_and_b32 v11, 0xffff0000, v25
    v_fmac_f32 v4, v8, v10
    v_fmac_f32 v5, v8, v11
    v_lshlrev_b32 v10, 16, v26
    v_and_b32 v11, 0xffff0000, v26
    v_fmac_f32 v6, v8, v10
    v_fmac_f32 v7, v8, v11
    s_waitcnt vmcnt(6)
    v_lshlrev_b32_e64 v8, v9, s59
    v_and_b32 v8, 0xffff0000, v8
    v_lshlrev_b32 v10, 16, v28
    v_and_b32 v11, 0xffff0000, v28
    v_fmac_f32 v2, v8, v10
    v_fmac_f32 v3, v8, v11
    v_lshlrev_b32 v10, 16, v29
    v_and_b32 v11, 0xffff0000, v29
    v_fmac_f32 v4, v8, v10
    v_fmac_f32 v5, v8, v11
    v_lshlrev_b32 v10, 16, v30
    v_and_b32 v11, 0xffff0000, v30
    v_fmac_f32 v6, v8, v10
    v_fmac_f32 v7, v8, v11
    s_waitcnt vmcnt(5)
    v_lshlrev_b32_e64 v8, v9, s60
    v_and_b32 v8, 0xffff0000, v8
    v_lshlrev_b32 v10, 16, v32
    v_and_b32 v11, 0xffff0000, v32
    v_fmac_f32 v2, v8, v10
    v_fmac_f32 v3, v8, v11
    v_lshlrev_b32 v10, 16, v33
    v_and_b32 v11, 0xffff0000, v33
    v_fmac_f32 v4, v8, v10
    v_fmac_f32 v5, v8, v11
    v_lshlrev_b32 v10, 16, v34
    v_and_b32 v11, 0xffff0000, v34
    v_fmac_f32 v6, v8, v10
    v_fmac_f32 v7, v8, v11
    s_waitcnt vmcnt(4)
    v_lshlrev_b32_e64 v8, v9, s61
    v_and_b32 v8, 0xffff0000, v8
    v_lshlrev_b32 v10, 16, v36
    v_and_b32 v11, 0xffff0000, v36
    v_fmac_f32 v2, v8, v10
    v_fmac_f32 v3, v8, v11
    v_lshlrev_b32 v10, 16, v37
    v_and_b32 v11, 0xffff0000, v37
    v_fmac_f32 v4, v8, v10
    v_fmac_f32 v5, v8, v11
    v_lshlrev_b32 v10, 16, v38
    v_and_b32 v11, 0xffff0000, v38
    v_fmac_f32 v6, v8, v10
    v_fmac_f32 v7, v8, v11
    s_waitcnt vmcnt(3)
    v_lshlrev_b32_e64 v8, v9, s62
    v_and_b32 v8, 0xffff0000, v8
    v_lshlrev_b32 v10, 16, v40
    v_and_b32 v11, 0xffff0000, v40
    v_fmac_f32 v2, v8, v10
    v_fmac_f32 v3, v8, v11
    v_lshlrev_b32 v10, 16, v41
    v_and_b32 v11, 0xffff0000, v41
    v_fmac_f32 v4, v8, v10
    v_fmac_f32 v5, v8, v11
    v_lshlrev_b32 v10, 16, v42
    v_and_b32 v11, 0xffff0000, v42
    v_fmac_f32 v6, v8, v10
    v_fmac_f32 v7, v8, v11
    s_waitcnt vmcnt(2)
    v_lshlrev_b32_e64 v8, v9, s63
    v_and_b32 v8, 0xffff0000, v8
    v_lshlrev_b32 v10, 16, v44
    v_and_b32 v11, 0xffff0000, v44
    v_fmac_f32 v2, v8, v10
    v_fmac_f32 v3, v8, v11
    v_lshlrev_b32 v10, 16, v45
    v_and_b32 v11, 0xffff0000, v45
    v_fmac_f32 v4, v8, v10
    v_fmac_f32 v5, v8, v11
    v_lshlrev_b32 v10, 16, v46
    v_and_b32 v11, 0xffff0000, v46
    v_fmac_f32 v6, v8, v10
    v_fmac_f32 v7, v8, v11
    s_waitcnt vmcnt(1)
    v_lshlrev_b32_e64 v8, v9, s64
    v_and_b32 v8, 0xffff0000, v8
    v_lshlrev_b32 v10, 16, v48
    v_and_b32 v11, 0xffff0000, v48
    v_fmac_f32 v2, v8, v10
    v_fmac_f32 v3, v8, v11
    v_lshlrev_b32 v10, 16, v49
    v_and_b32 v11, 0xffff0000, v49
    v_fmac_f32 v4, v8, v10
    v_fmac_f32 v5, v8, v11
    v_lshlrev_b32 v10, 16, v50
    v_and_b32 v11, 0xffff0000, v50
    v_fmac_f32 v6, v8, v10
    v_fmac_f32 v7, v8, v11
    s_waitcnt vmcnt(0)
    v_lshlrev_b32_e64 v8, v9, s65
    v_and_b32 v8, 0xffff0000, v8
    v_lshlrev_b32 v10, 16, v52
    v_and_b32 v11, 0xffff0000, v52
    v_fmac_f32 v2, v8, v10
    v_fmac_f32 v3, v8, v11
    v_lshlrev_b32 v10, 16, v53
    v_and_b32 v11, 0xffff0000, v53
    v_fmac_f32 v4, v8, v10
    v_fmac_f32 v5, v8, v11
    v_lshlrev_b32 v10, 16, v54
    v_and_b32 v11, 0xffff0000, v54
    v_fmac_f32 v6, v8, v10
    v_fmac_f32 v7, v8, v11
    v_and_b32 v1, 31, v0
    v_lshrrev_b32 v9, 5, v0
    v_mul_u32_u24 v1, 24, v1
    v_mul_u32_u24 v9, 768, v9
    v_add_u32 v1, v1, v9
    s_mul_i32 s52, s51, 1536
    v_add_u32 v1, s52, v1
    ds_write_b64 v1, v[2:3] offset:0
    ds_write_b64 v1, v[4:5] offset:8
    ds_write_b64 v1, v[6:7] offset:16
    s_cmp_lg_u32 s51, 0
    s_cbranch_scc1 L_q_nononce2
    v_cmp_eq_u32 vcc, 0, v12
    v_mov_b32 v13, s70
    v_mov_b32 v14, 6656
    v_cndmask_b32 v12, v12, v13, vcc
    s_mov_b64 exec, 1
    ds_write_b32 v14, v12
    s_mov_b64 exec, -1
L_q_nononce2:
    v_mov_b32 v126, 6692
    v_mov_b32 v127, 1
    s_mov_b64 s[68:69], exec
    s_mov_b64 exec, 1
    ds_add_u32 v126, v127
    s_mov_b64 exec, s[68:69]
    v_mov_b32 v126, 6692
    s_mov_b32 s69, 0
L_w1:
    ds_read_b32 v127, v126
    s_waitcnt lgkmcnt(0)
    v_readfirstlane_b32 s68, v127
    s_add_u32 s69, s69, 1
    s_cmp_ge_u32 s69, 1048576
    s_cbranch_scc1 L_w1d
    s_cmp_lt_u32 s68, 4
    s_cbranch_scc1 L_w1
L_w1d:
    v_mov_b32 v14, 6656
    ds_read_b32 v12, v14
    s_lshr_b32 s60, s51, 1
    s_and_b32 s61, s51, 1
    s_cmp_eq_u32 s61, 1
    s_cselect_b32 s67, 0, -1
    s_mov_b32 s66, -1
    s_mov_b64 exec, s[66:67]
    s_lshl_b32 s52, s61, 6
    v_add_u32 v1, s52, v0
    v_lshlrev_b32 v8, 3, v1
    ds_read_b64 v[16:17], v8 offset:0
    ds_read_b64 v[18:19], v8 offset:768
    ds_read_b64 v[20:21], v8 offset:1536
    ds_read_b64 v[22:23], v8 offset:2304
    ds_read_b64 v[24:25], v8 offset:3072
    ds_read_b64 v[26:27], v8 offset:3840
    ds_read_b64 v[28:29], v8 offset:4608
    ds_read_b64 v[30:31], v8 offset:5376
    s_waitcnt lgkmcnt(0)
    v_add_f32 v2, v16, v18
    v_add_f32 v3, v17, v19
    v_add_f32 v2, v2, v20
    v_add_f32 v3, v3, v21
    v_add_f32 v2, v2, v22
    v_add_f32 v3, v3, v23
    v_add_f32 v2, v2, v24
    v_add_f32 v3, v3, v25
    v_add_f32 v2, v2, v26
    v_add_f32 v3, v3, v27
    v_add_f32 v2, v2, v28
    v_add_f32 v3, v3, v29
    v_add_f32 v2, v2, v30
    v_add_f32 v3, v3, v31
    v_mov_b32 v4, v12
    v_xor_b32 v5, 2654435769, v12
    v_lshlrev_b32 v9, 4, v1
    s_mul_i32 s52, s48, 12288
    s_mul_i32 s53, s49, 1536
    s_add_u32 s53, s53, s52
    s_cmp_eq_u32 s60, 0
    s_cbranch_scc1 L_q_pubA1
    s_add_u32 s53, s53, 2097152
    buffer_store_dwordx4 v[2:5], v9, s[44:47], s53 offen sc1
    s_mov_b64 exec, -1
    s_branch L_q_afterq
L_q_pubA1:
    buffer_store_dwordx4 v[2:5], v9, s[44:47], s53 offen
    s_mov_b32 s68, 0
    s_cmp_ge_u32 s68, 8
    s_cselect_b32 s53, s68, 0
    s_and_b32 s53, s53, 1
    s_mul_i32 s53, s53, 2097152
    s_add_u32 s53, s53, s52
    s_add_u32 s68, s68, 1
    buffer_load_dwordx4 v[16:19], v9, s[44:47], s53 offen sc1
    s_add_u32 s53, s53, 1536
    buffer_load_dwordx4 v[20:23], v9, s[44:47], s53 offen sc1
    s_add_u32 s53, s53, 1536
    buffer_load_dwordx4 v[24:27], v9, s[44:47], s53 offen sc1
    s_add_u32 s53, s53, 1536
    buffer_load_dwordx4 v[28:31], v9, s[44:47], s53 offen sc1
    s_add_u32 s53, s53, 1536
    buffer_load_dwordx4 v[32:35], v9, s[44:47], s53 offen sc1
    s_add_u32 s53, s53, 1536
    buffer_load_dwordx4 v[36:39], v9, s[44:47], s53 offen sc1
    s_add_u32 s53, s53, 1536
    buffer_load_dwordx4 v[40:43], v9, s[44:47], s53 offen sc1
    s_add_u32 s53, s53, 1536
    buffer_load_dwordx4 v[44:47], v9, s[44:47], s53 offen sc1
    s_cmp_ge_u32 s68, 8
    s_cselect_b32 s53, s68, 0
    s_and_b32 s53, s53, 1
    s_mul_i32 s53, s53, 2097152
    s_add_u32 s53, s53, s52
    s_add_u32 s68, s68, 1
    buffer_load_dwordx4 v[48:51], v9, s[44:47], s53 offen sc1
    s_add_u32 s53, s53, 1536
    buffer_load_dwordx4 v[52:55], v9, s[44:47], s53 offen sc1
    s_add_u32 s53, s53, 1536
    buffer_load_dwordx4 v[56:59], v9, s[44:47], s53 offen sc1
    s_add_u32 s53, s53, 1536
    buffer_load_dwordx4 v[60:63], v9, s[44:47], s53 offen sc1
    s_add_u32 s53, s53, 1536
    buffer_load_dwordx4 v[64:67], v9, s[44:47], s53 offen sc1
    s_add_u32 s53, s53, 1536
    buffer_load_dwordx4 v[68:71], v9, s[44:47], s53 offen sc1
    s_add_u32 s53, s53, 1536
    buffer_load_dwordx4 v[72:75], v9, s[44:47], s53 offen sc1
    s_add_u32 s53, s53, 1536
    buffer_load_dwordx4 v[76:79], v9, s[44:47], s53 offen sc1
    s_cmp_ge_u32 s68, 8
    s_cselect_b32 s53, s68, 0
    s_and_b32 s53, s53, 1
    s_mul_i32 s53, s53, 2097152
    s_add_u32 s53, s53, s52
    s_add_u32 s68, s68, 1
    buffer_load_dwordx4 v[80:83], v9, s[44:47], s53 offen sc1
    s_add_u32 s53, s53, 1536
    buffer_load_dwordx4 v[84:87], v9, s[44:47], s53 offen sc1
    s_add_u32 s53, s53, 1536
    buffer_load_dwordx4 v[88:91], v9, s[44:47], s53 offen sc1
    s_add_u32 s53, s53, 1536
    buffer_load_dwordx4 v[92:95], v9, s[44:47], s53 offen sc1
    s_add_u32 s53, s53, 1536
    buffer_load_dwordx4 v[96:99], v9, s[44:47], s53 offen sc1
    s_add_u32 s53, s53, 1536
    buffer_load_dwordx4 v[100:103], v9, s[44:47], s53 offen sc1
    s_add_u32 s53, s53, 1536
    buffer_load_dwordx4 v[104:107], v9, s[44:47], s53 offen sc1
    s_add_u32 s53, s53, 1536
    buffer_load_dwordx4 v[108:111], v9, s[44:47], s53 offen sc1
L_q_poll1:
    s_waitcnt vmcnt(16)
    v_mov_b32 v10, 0
    v_xor_b32 v6, v18, v4
    v_xor_b32 v7, v19, v5
    v_or3_b32 v10, v10, v6, v7
    v_xor_b32 v6, v22, v4
    v_xor_b32 v7, v23, v5
    v_or3_b32 v10, v10, v6, v7
    v_xor_b32 v6, v26, v4
    v_xor_b32 v7, v27, v5
    v_or3_b32 v10, v10, v6, v7
    v_xor_b32 v6, v30, v4
    v_xor_b32 v7, v31, v5
    v_or3_b32 v10, v10, v6, v7
    v_xor_b32 v6, v34, v4
    v_xor_b32 v7, v35, v5
    v_or3_b32 v10, v10, v6, v7
    v_xor_b32 v6, v38, v4
    v_xor_b32 v7, v39, v5
    v_or3_b32 v10, v10, v6, v7
    v_xor_b32 v6, v42, v4
    v_xor_b32 v7, v43, v5
    v_or3_b32 v10, v10, v6, v7
    v_xor_b32 v6, v46, v4
    v_xor_b32 v7, v47, v5
    v_or3_b32 v10, v10, v6, v7
    v_cmp_ne_u32 vcc, 0, v10
    s_cmp_ge_u32 s68, 65536
    s_cbranch_scc1 L_q_p1ok0
    s_cbranch_vccz L_q_p1ok0
    s_cmp_ge_u32 s68, 8
    s_cselect_b32 s53, s68, 0
    s_and_b32 s53, s53, 1
    s_mul_i32 s53, s53, 2097152
    s_add_u32 s53, s53, s52
    s_add_u32 s68, s68, 1
    buffer_load_dwordx4 v[16:19], v9, s[44:47], s53 offen sc1
    s_add_u32 s53, s53, 1536
    buffer_load_dwordx4 v[20:23], v9, s[44:47], s53 offen sc1
    s_add_u32 s53, s53, 1536
    buffer_load_dwordx4 v[24:27], v9, s[44:47], s53 offen sc1
    s_add_u32 s53, s53, 1536
    buffer_load_dwordx4 v[28:31], v9, s[44:47], s53 offen sc1
    s_add_u32 s53, s53, 1536
    buffer_load_dwordx4 v[32:35], v9, s[44:47], s53 offen sc1
    s_add_u32 s53, s53, 1536
    buffer_load_dwordx4 v[36:39], v9, s[44:47], s53 offen sc1
    s_add_u32 s53, s53, 1536
    buffer_load_dwordx4 v[40:43], v9, s[44:47], s53 offen sc1
    s_add_u32 s53, s53, 1536
    buffer_load_dwordx4 v[44:47], v9, s[44:47], s53 offen sc1
    s_waitcnt vmcnt(16)
    v_mov_b32 v10, 0
    v_xor_b32 v6, v50, v4
    v_xor_b32 v7, v51, v5
    v_or3_b32 v10, v10, v6, v7
    v_xor_b32 v6, v54, v4
    v_xor_b32 v7, v55, v5
    v_or3_b32 v10, v10, v6, v7
    v_xor_b32 v6, v58, v4
    v_xor_b32 v7, v59, v5
    v_or3_b32 v10, v10, v6, v7
    v_xor_b32 v6, v62, v4
    v_xor_b32 v7, v63, v5
    v_or3_b32 v10, v10, v6, v7
    v_xor_b32 v6, v66, v4
    v_xor_b32 v7, v67, v5
    v_or3_b32 v10, v10, v6, v7
    v_xor_b32 v6, v70, v4
    v_xor_b32 v7, v71, v5
    v_or3_b32 v10, v10, v6, v7
    v_xor_b32 v6, v74, v4
    v_xor_b32 v7, v75, v5
    v_or3_b32 v10, v10, v6, v7
    v_xor_b32 v6, v78, v4
    v_xor_b32 v7, v79, v5
    v_or3_b32 v10, v10, v6, v7
    v_cmp_ne_u32 vcc, 0, v10
    s_cmp_ge_u32 s68, 65536
    s_cbranch_scc1 L_q_p1ok1
    s_cbranch_vccz L_q_p1ok1
    s_cmp_ge_u32 s68, 8
    s_cselect_b32 s53, s68, 0
    s_and_b32 s53, s53, 1
    s_mul_i32 s53, s53, 2097152
    s_add_u32 s53, s53, s52
    s_add_u32 s68, s68, 1
    buffer_load_dwordx4 v[48:51], v9, s[44:47], s53 offen sc1
    s_add_u32 s53, s53, 1536
    buffer_load_dwordx4 v[52:55], v9, s[44:47], s53 offen sc1
    s_add_u32 s53, s53, 1536
    buffer_load_dwordx4 v[56:59], v9, s[44:47], s53 offen sc1
    s_add_u32 s53, s53, 1536
    buffer_load_dwordx4 v[60:63], v9, s[44:47], s53 offen sc1
    s_add_u32 s53, s53, 1536
    buffer_load_dwordx4 v[64:67], v9, s[44:47], s53 offen sc1
    s_add_u32 s53, s53, 1536
    buffer_load_dwordx4 v[68:71], v9, s[44:47], s53 offen sc1
    s_add_u32 s53, s53, 1536
    buffer_load_dwordx4 v[72:75], v9, s[44:47], s53 offen sc1
    s_add_u32 s53, s53, 1536
    buffer_load_dwordx4 v[76:79], v9, s[44:47], s53 offen sc1
    s_waitcnt vmcnt(16)
    v_mov_b32 v10, 0
    v_xor_b32 v6, v82, v4
    v_xor_b32 v7, v83, v5
    v_or3_b32 v10, v10, v6, v7
    v_xor_b32 v6, v86, v4
    v_xor_b32 v7, v87, v5
    v_or3_b32 v10, v10, v6, v7
    v_xor_b32 v6, v90, v4
    v_xor_b32 v7, v91, v5
    v_or3_b32 v10, v10, v6, v7
    v_xor_b32 v6, v94, v4
    v_xor_b32 v7, v95, v5
    v_or3_b32 v10, v10, v6, v7
    v_xor_b32 v6, v98, v4
    v_xor_b32 v7, v99, v5
    v_or3_b32 v10, v10, v6, v7
    v_xor_b32 v6, v102, v4
    v_xor_b32 v7, v103, v5
    v_or3_b32 v10, v10, v6, v7
    v_xor_b32 v6, v106, v4
    v_xor_b32 v7, v107, v5
    v_or3_b32 v10, v10, v6, v7
    v_xor_b32 v6, v110, v4
    v_xor_b32 v7, v111, v5
    v_or3_b32 v10, v10, v6, v7
    v_cmp_ne_u32 vcc, 0, v10
    s_cmp_ge_u32 s68, 65536
    s_cbranch_scc1 L_q_p1ok2
    s_cbranch_vccz L_q_p1ok2
    s_cmp_ge_u32 s68, 8
    s_cselect_b32 s53, s68, 0
    s_and_b32 s53, s53, 1
    s_mul_i32 s53, s53, 2097152
    s_add_u32 s53, s53, s52
    s_add_u32 s68, s68, 1
    buffer_load_dwordx4 v[80:83], v9, s[44:47], s53 offen sc1
    s_add_u32 s53, s53, 1536
    buffer_load_dwordx4 v[84:87], v9, s[44:47], s53 offen sc1
    s_add_u32 s53, s53, 1536
    buffer_load_dwordx4 v[88:91], v9, s[44:47], s53 offen sc1
    s_add_u32 s53, s53, 1536
    buffer_load_dwordx4 v[92:95], v9, s[44:47], s53 offen sc1
    s_add_u32 s53, s53, 1536
    buffer_load_dwordx4 v[96:99], v9, s[44:47], s53 offen sc1
    s_add_u32 s53, s53, 1536
    buffer_load_dwordx4 v[100:103], v9, s[44:47], s53 offen sc1
    s_add_u32 s53, s53, 1536
    buffer_load_dwordx4 v[104:107], v9, s[44:47], s53 offen sc1
    s_add_u32 s53, s53, 1536
    buffer_load_dwordx4 v[108:111], v9, s[44:47], s53 offen sc1
    s_branch L_q_poll1
L_q_p1ok0:
    v_add_f32 v2, v16, v20
    v_add_f32 v3, v17, v21
    v_add_f32 v2, v2, v24
    v_add_f32 v3, v3, v25
    v_add_f32 v2, v2, v28
    v_add_f32 v3, v3, v29
    v_add_f32 v2, v2, v32
    v_add_f32 v3, v3, v33
    v_add_f32 v2, v2, v36
    v_add_f32 v3, v3, v37
    v_add_f32 v2, v2, v40
    v_add_f32 v3, v3, v41
    v_add_f32 v2, v2, v44
    v_add_f32 v3, v3, v45
    s_branch L_q_p1done
L_q_p1ok1:
    v_add_f32 v2, v48, v52
    v_add_f32 v3, v49, v53
    v_add_f32 v2, v2, v56
    v_add_f32 v3, v3, v57
    v_add_f32 v2, v2, v60
    v_add_f32 v3, v3, v61
    v_add_f32 v2, v2, v64
    v_add_f32 v3, v3, v65
    v_add_f32 v2, v2, v68
    v_add_f32 v3, v3, v69
    v_add_f32 v2, v2, v72
    v_add_f32 v3, v3, v73
    v_add_f32 v2, v2, v76
    v_add_f32 v3, v3, v77
    s_branch L_q_p1done
L_q_p1ok2:
    v_add_f32 v2, v80, v84
    v_add_f32 v3, v81, v85
    v_add_f32 v2, v2, v88
    v_add_f32 v3, v3, v89
    v_add_f32 v2, v2, v92
    v_add_f32 v3, v3, v93
    v_add_f32 v2, v2, v96
    v_add_f32 v3, v3, v97
    v_add_f32 v2, v2, v100
    v_add_f32 v3, v3, v101
    v_add_f32 v2, v2, v104
    v_add_f32 v3, v3, v105
    v_add_f32 v2, v2, v108
    v_add_f32 v3, v3, v109
L_q_p1done:
    v_cvt_pk_bf16_f32 v2, v2, v3
    v_lshlrev_b32 v8, 2, v1
    ds_write_b32 v8, v2 offset:6144
    s_mov_b64 exec, -1
    v_mov_b32 v126, 6696
    v_mov_b32 v127, 1
    s_mov_b64 s[68:69], exec
    s_mov_b64 exec, 1
    ds_add_u32 v126, v127
    s_mov_b64 exec, s[68:69]
L_q_afterq:
    v_mov_b32 v126, 6704
    s_mov_b32 s69, 0
L_w2:
    ds_read_b32 v127, v126
    s_waitcnt lgkmcnt(0)
    v_readfirstlane_b32 s68, v127
    s_add_u32 s69, s69, 1
    s_cmp_ge_u32 s69, 1048576
    s_cbranch_scc1 L_w2d
    s_cmp_lt_u32 s68, 4
    s_cbranch_scc1 L_w2
L_w2d:
    s_waitcnt vmcnt(0)
    s_mov_b64 exec, s[66:67]
    v_lshlrev_b32 v8, 3, v1
    v_mov_b32 v14, 7424
    ds_read_b128 v[48:51], v14
    ds_read_b128 v[52:55], v14 offset:16
    ds_read_b32 v15, v14 offset:32
    ds_read_b64 v[16:17], v8 offset:8704
    ds_read_b64 v[18:19], v8 offset:9472
    ds_read_b64 v[20:21], v8 offset:10240
    ds_read_b64 v[22:23], v8 offset:11008
    ds_read_b64 v[24:25], v8 offset:11776
    ds_read_b64 v[26:27], v8 offset:12544
    ds_read_b64 v[28:29], v8 offset:13312
    ds_read_b64 v[30:31], v8 offset:14080
    s_waitcnt lgkmcnt(0)
    v_add_f32 v2, v16, v18
    v_add_f32 v3, v17, v19
    v_add_f32 v2, v2, v20
    v_add_f32 v3, v3, v21
    v_add_f32 v2, v2, v22
    v_add_f32 v3, v3, v23
    v_add_f32 v2, v2, v24
    v_add_f32 v3, v3, v25
    v_add_f32 v2, v2, v26
    v_add_f32 v3, v3, v27
    v_add_f32 v2, v2, v28
    v_add_f32 v3, v3, v29
    v_add_f32 v2, v2, v30
    v_add_f32 v3, v3, v31
    v_add_f32 v7, v48, v49
    v_add_f32 v7, v7, v50
    v_add_f32 v7, v7, v51
    v_add_f32 v7, v7, v52
    v_add_f32 v7, v7, v53
    v_add_f32 v7, v7, v54
    v_add_f32 v7, v7, v55
    s_lshl_b32 s52, s48, 14
    s_add_u32 s52, s52, 524288
    s_lshl_b32 s53, s49, 11
    s_add_u32 s53, s53, s52
    v_mov_b32 v13, 1536
    v_mov_b32 v48, v15
    v_mov_b32 v49, v7
    v_mov_b32 v50, v4
    v_mov_b32 v51, v5
    s_cmp_eq_u32 s60, 0
    s_cbranch_scc1 L_q_pubA2
    s_add_u32 s53, s53, 2097152
    buffer_store_dwordx4 v[2:5], v9, s[44:47], s53 offen sc1
    s_mov_b64 exec, -1
    s_cmp_lg_u32 s61, 0
    s_cbranch_scc1 L_q_skip1
    s_mov_b64 exec, 1
    buffer_store_dwordx4 v[48:51], v13, s[44:47], s53 offen sc1
    s_mov_b64 exec, -1
    s_branch L_q_skip1
L_q_pubA2:
    buffer_store_dwordx4 v[2:5], v9, s[44:47], s53 offen
    s_cmp_lg_u32 s61, 0
    s_cbranch_scc1 L_q_noml
    s_mov_b64 exec, 1
    buffer_store_dwordx4 v[48:51], v13, s[44:47], s53 offen
    s_mov_b64 exec, s[66:67]
L_q_noml:
    s_mov_b32 s68, 0
    v_and_b32 v13, 7, v0
    v_lshlrev_b32 v13, 11, v13
    v_add_u32 v13, 1536, v13
    s_mov_b32 s58, 1069066811
    s_cmp_ge_u32 s68, 8
    s_cselect_b32 s53, s68, 0
    s_and_b32 s53, s53, 1
    s_mul_i32 s53, s53, 2097152
    s_add_u32 s53, s53, s52
    s_add_u32 s68, s68, 1
    buffer_load_dwordx4 v[48:51], v13, s[44:47], s53 offen sc1
    buffer_load_dwordx4 v[16:19], v9, s[44:47], s53 offen sc1
    s_add_u32 s53, s53, 2048
    buffer_load_dwordx4 v[20:23], v9, s[44:47], s53 offen sc1
    s_add_u32 s53, s53, 2048
    buffer_load_dwordx4 v[24:27], v9, s[44:47], s53 offen sc1
    s_add_u32 s53, s53, 2048
    buffer_load_dwordx4 v[28:31], v9, s[44:47], s53 offen sc1
    s_add_u32 s53, s53, 2048
    buffer_load_dwordx4 v[32:35], v9, s[44:47], s53 offen sc1
    s_add_u32 s53, s53, 2048
    buffer_load_dwordx4 v[36:39], v9, s[44:47], s53 offen sc1
    s_add_u32 s53, s53, 2048
    buffer_load_dwordx4 v[40:43], v9, s[44:47], s53 offen sc1
    s_add_u32 s53, s53, 2048
    buffer_load_dwordx4 v[44:47], v9, s[44:47], s53 offen sc1
L_q_poll2:
    s_waitcnt vmcnt(0)
    v_xor_b32 v6, v50, v4
    v_xor_b32 v7, v51, v5
    v_or_b32 v10, v6, v7
    v_xor_b32 v6, v18, v4
    v_xor_b32 v7, v19, v5
    v_or3_b32 v10, v10, v6, v7
    v_xor_b32 v6, v22, v4
    v_xor_b32 v7, v23, v5
    v_or3_b32 v10, v10, v6, v7
    v_xor_b32 v6, v26, v4
    v_xor_b32 v7, v27, v5
    v_or3_b32 v10, v10, v6, v7
    v_xor_b32 v6, v30, v4
    v_xor_b32 v7, v31, v5
    v_or3_b32 v10, v10, v6, v7
    v_xor_b32 v6, v34, v4
    v_xor_b32 v7, v35, v5
    v_or3_b32 v10, v10, v6, v7
    v_xor_b32 v6, v38, v4
    v_xor_b32 v7, v39, v5
    v_or3_b32 v10, v10, v6, v7
    v_xor_b32 v6, v42, v4
    v_xor_b32 v7, v43, v5
    v_or3_b32 v10, v10, v6, v7
    v_xor_b32 v6, v46, v4
    v_xor_b32 v7, v47, v5
    v_or3_b32 v10, v10, v6, v7
    v_cmp_ne_u32 vcc, 0, v10
    s_cmp_ge_u32 s68, 65536
    s_cbranch_scc1 L_q_p2ok0
    s_cbranch_vccz L_q_p2ok0
    s_cmp_ge_u32 s68, 8
    s_cselect_b32 s53, s68, 0
    s_and_b32 s53, s53, 1
    s_mul_i32 s53, s53, 2097152
    s_add_u32 s53, s53, s52
    s_add_u32 s68, s68, 1
    buffer_load_dwordx4 v[48:51], v13, s[44:47], s53 offen sc1
    buffer_load_dwordx4 v[16:19], v9, s[44:47], s53 offen sc1
    s_add_u32 s53, s53, 2048
    buffer_load_dwordx4 v[20:23], v9, s[44:47], s53 offen sc1
    s_add_u32 s53, s53, 2048
    buffer_load_dwordx4 v[24:27], v9, s[44:47], s53 offen sc1
    s_add_u32 s53, s53, 2048
    buffer_load_dwordx4 v[28:31], v9, s[44:47], s53 offen sc1
    s_add_u32 s53, s53, 2048
    buffer_load_dwordx4 v[32:35], v9, s[44:47], s53 offen sc1
    s_add_u32 s53, s53, 2048
    buffer_load_dwordx4 v[36:39], v9, s[44:47], s53 offen sc1
    s_add_u32 s53, s53, 2048
    buffer_load_dwordx4 v[40:43], v9, s[44:47], s53 offen sc1
    s_add_u32 s53, s53, 2048
    buffer_load_dwordx4 v[44:47], v9, s[44:47], s53 offen sc1
    s_branch L_q_poll2
L_q_p2ok0:
    v_max_f32_dpp v6, v48, v48 quad_perm:[1,0,3,2] row_mask:0xf bank_mask:0xf
    s_nop 1
    v_max_f32_dpp v6, v6, v6 quad_perm:[2,3,0,1] row_mask:0xf bank_mask:0xf
    s_nop 1
    v_max_f32_dpp v6, v6, v6 row_half_mirror row_mask:0xf bank_mask:0xf
    v_sub_f32 v6, v48, v6
    v_mul_f32 v6, s58, v6
    v_exp_f32 v6, v6
    s_nop 0
    v_mul_f32 v7, v6, v49
    s_nop 1
    v_add_f32_dpp v7, v7, v7 quad_perm:[1,0,3,2] row_mask:0xf bank_mask:0xf
    s_nop 1
    v_add_f32_dpp v7, v7, v7 quad_perm:[2,3,0,1] row_mask:0xf bank_mask:0xf
    s_nop 1
    v_add_f32_dpp v7, v7, v7 row_half_mirror row_mask:0xf bank_mask:0xf
    v_readlane_b32 s56, v6, 0
    v_readlane_b32 s57, v6, 1
    v_readlane_b32 s59, v6, 2
    v_readlane_b32 s60, v6, 3
    v_readlane_b32 s61, v6, 4
    v_readlane_b32 s62, v6, 5
    v_readlane_b32 s63, v6, 6
    v_readlane_b32 s64, v6, 7
    v_mov_b32 v2, 0
    v_mov_b32 v3, 0
    v_fmac_f32 v2, s56, v16
    v_fmac_f32 v3, s56, v17
    v_fmac_f32 v2, s57, v20
    v_fmac_f32 v3, s57, v21
    v_fmac_f32 v2, s59, v24
    v_fmac_f32 v3, s59, v25
    v_fmac_f32 v2, s60, v28
    v_fmac_f32 v3, s60, v29
    v_fmac_f32 v2, s61, v32
    v_fmac_f32 v3, s61, v33
    v_fmac_f32 v2, s62, v36
    v_fmac_f32 v3, s62, v37
    v_fmac_f32 v2, s63, v40
    v_fmac_f32 v3, s63, v41
    v_fmac_f32 v2, s64, v44
    v_fmac_f32 v3, s64, v45
L_q_p2done:
    v_rcp_f32 v7, v7
    s_nop 0
    v_mul_f32 v2, v2, v7
    v_mul_f32 v3, v3, v7
    v_cvt_pk_bf16_f32 v6, v2, v3
    v_lshlrev_b32 v2, 16, v6
    v_and_b32 v3, 0xffff0000, v6
    v_lshlrev_b32 v8, 3, v1
    ds_write_b64 v8, v[2:3] offset:7680
    s_mov_b64 exec, -1
    v_mov_b32 v126, 6708
    v_mov_b32 v127, 1
    s_mov_b64 s[68:69], exec
    s_mov_b64 exec, 1
    ds_add_u32 v126, v127
    s_mov_b64 exec, s[68:69]
L_q_skip1:
    s_mov_b32 s66, -1
    s_mov_b32 s67, 0xff
    v_lshlrev_b32 v9, 4, v0
    v_lshlrev_b32 v8, 3, v0
    s_cmp_lg_u32 s51, 0
    s_cbranch_scc1 L_q_nopub
    v_mov_b32 v126, 6712
    s_mov_b32 s69, 0
L_w3:
    ds_read_b32 v127, v126
    s_waitcnt lgkmcnt(0)
    v_readfirstlane_b32 s68, v127
    s_add_u32 s69, s69, 1
    s_cmp_ge_u32 s69, 1048576
    s_cbranch_scc1 L_w3d
    s_cmp_lt_u32 s68, 4
    s_cbranch_scc1 L_w3
L_w3d:
    s_waitcnt vmcnt(0)
    s_mov_b64 exec, s[66:67]
    ds_read_b64 v[16:17], v8 offset:14848
    ds_read_b64 v[18:19], v8 offset:15168
    ds_read_b64 v[20:21], v8 offset:15488
    ds_read_b64 v[22:23], v8 offset:15808
    ds_read_b64 v[24:25], v8 offset:16128
    ds_read_b64 v[26:27], v8 offset:16448
    ds_read_b64 v[28:29], v8 offset:16768
    ds_read_b64 v[30:31], v8 offset:17088
    ds_read_b64 v[32:33], v8 offset:17408
    ds_read_b64 v[34:35], v8 offset:17728
    ds_read_b64 v[36:37], v8 offset:18048
    ds_read_b64 v[38:39], v8 offset:18368
    ds_read_b64 v[40:41], v8 offset:18688
    ds_read_b64 v[42:43], v8 offset:19008
    ds_read_b64 v[44:45], v8 offset:19328
    ds_read_b64 v[46:47], v8 offset:19648
    ds_read_b64 v[48:49], v8 offset:19968
    ds_read_b64 v[50:51], v8 offset:20288
    ds_read_b64 v[52:53], v8 offset:20608
    ds_read_b64 v[54:55], v8 offset:20928
    ds_read_b64 v[56:57], v8 offset:21248
    ds_read_b64 v[58:59], v8 offset:21568
    ds_read_b64 v[60:61], v8 offset:21888
    ds_read_b64 v[62:63], v8 offset:22208
    s_waitcnt lgkmcnt(0)
    v_add_f32 v2, v16, v18
    v_add_f32 v3, v17, v19
    v_add_f32 v2, v2, v20
    v_add_f32 v3, v3, v21
    v_add_f32 v2, v2, v22
    v_add_f32 v3, v3, v23
    v_add_f32 v2, v2, v24
    v_add_f32 v3, v3, v25
    v_add_f32 v2, v2, v26
    v_add_f32 v3, v3, v27
    v_add_f32 v2, v2, v28
    v_add_f32 v3, v3, v29
    v_add_f32 v2, v2, v30
    v_add_f32 v3, v3, v31
    v_add_f32 v2, v2, v32
    v_add_f32 v3, v3, v33
    v_add_f32 v2, v2, v34
    v_add_f32 v3, v3, v35
    v_add_f32 v2, v2, v36
    v_add_f32 v3, v3, v37
    v_add_f32 v2, v2, v38
    v_add_f32 v3, v3, v39
    v_add_f32 v2, v2, v40
    v_add_f32 v3, v3, v41
    v_add_f32 v2, v2, v42
    v_add_f32 v3, v3, v43
    v_add_f32 v2, v2, v44
    v_add_f32 v3, v3, v45
    v_add_f32 v2, v2, v46
    v_add_f32 v3, v3, v47
    v_add_f32 v2, v2, v48
    v_add_f32 v3, v3, v49
    v_add_f32 v2, v2, v50
    v_add_f32 v3, v3, v51
    v_add_f32 v2, v2, v52
    v_add_f32 v3, v3, v53
    v_add_f32 v2, v2, v54
    v_add_f32 v3, v3, v55
    v_add_f32 v2, v2, v56
    v_add_f32 v3, v3, v57
    v_add_f32 v2, v2, v58
    v_add_f32 v3, v3, v59
    v_add_f32 v2, v2, v60
    v_add_f32 v3, v3, v61
    v_add_f32 v2, v2, v62
    v_add_f32 v3, v3, v63
    v_mov_b32 v4, v12
    v_xor_b32 v5, 2654435769, v12
    s_lshl_b32 s52, s49, 5
    s_add_u32 s52, s52, s48
    s_lshl_b32 s52, s52, 10
    s_add_u32 s52, s52, 1048576
    buffer_store_dwordx4 v[2:5], v9, s[44:47], s52 offen sc1
L_q_nopub:
    s_mov_b64 exec, s[66:67]
    s_cmp_lg_u32 s48, s49
    s_cbranch_scc1 L_q_end
    s_lshl_b32 s52, s49, 5
    s_lshl_b32 s53, s51, 3
    s_add_u32 s52, s52, s53
    s_lshl_b32 s52, s52, 10
    s_add_u32 s52, s52, 1048576
    s_lshl_b32 s53, s51, 5
    s_add_u32 s53, s53, 128
    v_mov_b32 v14, s53
    s_mov_b32 s68, 0
    s_mov_b32 s53, s52
    s_add_u32 s68, s68, 1
    buffer_load_dwordx4 v[48:51], v14, s[40:43], 0 offen sc1
    buffer_load_dwordx4 v[52:55], v14, s[40:43], 0 offen offset:16 sc1
    buffer_load_dwordx4 v[16:19], v9, s[44:47], s53 offen sc1
    s_add_u32 s53, s53, 1024
    buffer_load_dwordx4 v[20:23], v9, s[44:47], s53 offen sc1
    s_add_u32 s53, s53, 1024
    buffer_load_dwordx4 v[24:27], v9, s[44:47], s53 offen sc1
    s_add_u32 s53, s53, 1024
    buffer_load_dwordx4 v[28:31], v9, s[44:47], s53 offen sc1
    s_add_u32 s53, s53, 1024
    buffer_load_dwordx4 v[32:35], v9, s[44:47], s53 offen sc1
    s_add_u32 s53, s53, 1024
    buffer_load_dwordx4 v[36:39], v9, s[44:47], s53 offen sc1
    s_add_u32 s53, s53, 1024
    buffer_load_dwordx4 v[40:43], v9, s[44:47], s53 offen sc1
    s_add_u32 s53, s53, 1024
    buffer_load_dwordx4 v[44:47], v9, s[44:47], s53 offen sc1
    s_mov_b32 s53, s52
    s_add_u32 s68, s68, 1
    buffer_load_dwordx4 v[88:91], v14, s[40:43], 0 offen sc1
    buffer_load_dwordx4 v[92:95], v14, s[40:43], 0 offen offset:16 sc1
    buffer_load_dwordx4 v[56:59], v9, s[44:47], s53 offen sc1
    s_add_u32 s53, s53, 1024
    buffer_load_dwordx4 v[60:63], v9, s[44:47], s53 offen sc1
    s_add_u32 s53, s53, 1024
    buffer_load_dwordx4 v[64:67], v9, s[44:47], s53 offen sc1
    s_add_u32 s53, s53, 1024
    buffer_load_dwordx4 v[68:71], v9, s[44:47], s53 offen sc1
    s_add_u32 s53, s53, 1024
    buffer_load_dwordx4 v[72:75], v9, s[44:47], s53 offen sc1
    s_add_u32 s53, s53, 1024
    buffer_load_dwordx4 v[76:79], v9, s[44:47], s53 offen sc1
    s_add_u32 s53, s53, 1024
    buffer_load_dwordx4 v[80:83], v9, s[44:47], s53 offen sc1
    s_add_u32 s53, s53, 1024
    buffer_load_dwordx4 v[84:87], v9, s[44:47], s53 offen sc1
L_r_poll:
    s_waitcnt vmcnt(10)
    v_mov_b32 v10, 0
    v_xor_b32 v6, v18, v48
    v_xor_b32 v7, 2654435769, v48
    v_xor_b32 v7, v19, v7
    v_or3_b32 v10, v10, v6, v7
    v_xor_b32 v6, v22, v49
    v_xor_b32 v7, 2654435769, v49
    v_xor_b32 v7, v23, v7
    v_or3_b32 v10, v10, v6, v7
    v_xor_b32 v6, v26, v50
    v_xor_b32 v7, 2654435769, v50
    v_xor_b32 v7, v27, v7
    v_or3_b32 v10, v10, v6, v7
    v_xor_b32 v6, v30, v51
    v_xor_b32 v7, 2654435769, v51
    v_xor_b32 v7, v31, v7
    v_or3_b32 v10, v10, v6, v7
    v_xor_b32 v6, v34, v52
    v_xor_b32 v7, 2654435769, v52
    v_xor_b32 v7, v35, v7
    v_or3_b32 v10, v10, v6, v7
    v_xor_b32 v6, v38, v53
    v_xor_b32 v7, 2654435769, v53
    v_xor_b32 v7, v39, v7
    v_or3_b32 v10, v10, v6, v7
    v_xor_b32 v6, v42, v54
    v_xor_b32 v7, 2654435769, v54
    v_xor_b32 v7, v43, v7
    v_or3_b32 v10, v10, v6, v7
    v_xor_b32 v6, v46, v55
    v_xor_b32 v7, 2654435769, v55
    v_xor_b32 v7, v47, v7
    v_or3_b32 v10, v10, v6, v7
    v_cmp_ne_u32 vcc, 0, v10
    s_cmp_ge_u32 s68, 65536
    s_cbranch_scc1 L_r_ok0
    s_cbranch_vccz L_r_ok0
    s_mov_b32 s53, s52
    s_add_u32 s68, s68, 1
    buffer_load_dwordx4 v[48:51], v14, s[40:43], 0 offen sc1
    buffer_load_dwordx4 v[52:55], v14, s[40:43], 0 offen offset:16 sc1
    buffer_load_dwordx4 v[16:19], v9, s[44:47], s53 offen sc1
    s_add_u32 s53, s53, 1024
    buffer_load_dwordx4 v[20:23], v9, s[44:47], s53 offen sc1
    s_add_u32 s53, s53, 1024
    buffer_load_dwordx4 v[24:27], v9, s[44:47], s53 offen sc1
    s_add_u32 s53, s53, 1024
    buffer_load_dwordx4 v[28:31], v9, s[44:47], s53 offen sc1
    s_add_u32 s53, s53, 1024
    buffer_load_dwordx4 v[32:35], v9, s[44:47], s53 offen sc1
    s_add_u32 s53, s53, 1024
    buffer_load_dwordx4 v[36:39], v9, s[44:47], s53 offen sc1
    s_add_u32 s53, s53, 1024
    buffer_load_dwordx4 v[40:43], v9, s[44:47], s53 offen sc1
    s_add_u32 s53, s53, 1024
    buffer_load_dwordx4 v[44:47], v9, s[44:47], s53 offen sc1
    s_waitcnt vmcnt(10)
    v_mov_b32 v10, 0
    v_xor_b32 v6, v58, v88
    v_xor_b32 v7, 2654435769, v88
    v_xor_b32 v7, v59, v7
    v_or3_b32 v10, v10, v6, v7
    v_xor_b32 v6, v62, v89
    v_xor_b32 v7, 2654435769, v89
    v_xor_b32 v7, v63, v7
    v_or3_b32 v10, v10, v6, v7
    v_xor_b32 v6, v66, v90
    v_xor_b32 v7, 2654435769, v90
    v_xor_b32 v7, v67, v7
    v_or3_b32 v10, v10, v6, v7
    v_xor_b32 v6, v70, v91
    v_xor_b32 v7, 2654435769, v91
    v_xor_b32 v7, v71, v7
    v_or3_b32 v10, v10, v6, v7
    v_xor_b32 v6, v74, v92
    v_xor_b32 v7, 2654435769, v92
    v_xor_b32 v7, v75, v7
    v_or3_b32 v10, v10, v6, v7
    v_xor_b32 v6, v78, v93
    v_xor_b32 v7, 2654435769, v93
    v_xor_b32 v7, v79, v7
    v_or3_b32 v10, v10, v6, v7
    v_xor_b32 v6, v82, v94
    v_xor_b32 v7, 2654435769, v94
    v_xor_b32 v7, v83, v7
    v_or3_b32 v10, v10, v6, v7
    v_xor_b32 v6, v86, v95
    v_xor_b32 v7, 2654435769, v95
    v_xor_b32 v7, v87, v7
    v_or3_b32 v10, v10, v6, v7
    v_cmp_ne_u32 vcc, 0, v10
    s_cmp_ge_u32 s68, 65536
    s_cbranch_scc1 L_r_ok1
    s_cbranch_vccz L_r_ok1
    s_mov_b32 s53, s52
    s_add_u32 s68, s68, 1
    buffer_load_dwordx4 v[88:91], v14, s[40:43], 0 offen sc1
    buffer_load_dwordx4 v[92:95], v14, s[40:43], 0 offen offset:16 sc1
    buffer_load_dwordx4 v[56:59], v9, s[44:47], s53 offen sc1
    s_add_u32 s53, s53, 1024
    buffer_load_dwordx4 v[60:63], v9, s[44:47], s53 offen sc1
    s_add_u32 s53, s53, 1024
    buffer_load_dwordx4 v[64:67], v9, s[44:47], s53 offen sc1
    s_add_u32 s53, s53, 1024
    buffer_load_dwordx4 v[68:71], v9, s[44:47], s53 offen sc1
    s_add_u32 s53, s53, 1024
    buffer_load_dwordx4 v[72:75], v9, s[44:47], s53 offen sc1
    s_add_u32 s53, s53, 1024
    buffer_load_dwordx4 v[76:79], v9, s[44:47], s53 offen sc1
    s_add_u32 s53, s53, 1024
    buffer_load_dwordx4 v[80:83], v9, s[44:47], s53 offen sc1
    s_add_u32 s53, s53, 1024
    buffer_load_dwordx4 v[84:87], v9, s[44:47], s53 offen sc1
    s_branch L_r_poll
L_r_ok0:
    v_add_f32 v2, v16, v20
    v_add_f32 v3, v17, v21
    v_add_f32 v2, v2, v24
    v_add_f32 v3, v3, v25
    v_add_f32 v2, v2, v28
    v_add_f32 v3, v3, v29
    v_add_f32 v2, v2, v32
    v_add_f32 v3, v3, v33
    v_add_f32 v2, v2, v36
    v_add_f32 v3, v3, v37
    v_add_f32 v2, v2, v40
    v_add_f32 v3, v3, v41
    v_add_f32 v2, v2, v44
    v_add_f32 v3, v3, v45
    s_branch L_r_done
L_r_ok1:
    v_add_f32 v2, v56, v60
    v_add_f32 v3, v57, v61
    v_add_f32 v2, v2, v64
    v_add_f32 v3, v3, v65
    v_add_f32 v2, v2, v68
    v_add_f32 v3, v3, v69
    v_add_f32 v2, v2, v72
    v_add_f32 v3, v3, v73
    v_add_f32 v2, v2, v76
    v_add_f32 v3, v3, v77
    v_add_f32 v2, v2, v80
    v_add_f32 v3, v3, v81
    v_add_f32 v2, v2, v84
    v_add_f32 v3, v3, v85
L_r_done:
    s_mul_i32 s53, s51, 320
    v_add_u32 v4, s53, v8
    ds_write_b64 v4, v[2:3] offset:22528
    s_mov_b64 exec, -1
    v_mov_b32 v126, 6716
    v_mov_b32 v127, 1
    s_mov_b64 s[68:69], exec
    s_mov_b64 exec, 1
    ds_add_u32 v126, v127
    s_mov_b64 exec, s[68:69]
    s_cmp_lg_u32 s51, 0
    s_cbranch_scc1 L_q_end
    v_mov_b32 v126, 6716
    s_mov_b32 s69, 0
L_w4:
    ds_read_b32 v127, v126
    s_waitcnt lgkmcnt(0)
    v_readfirstlane_b32 s68, v127
    s_add_u32 s69, s69, 1
    s_cmp_ge_u32 s69, 1048576
    s_cbranch_scc1 L_w4d
    s_cmp_lt_u32 s68, 4
    s_cbranch_scc1 L_w4
L_w4d:
    s_mov_b64 exec, s[66:67]
    ds_read_b64 v[120:121], v8 offset:22528
    ds_read_b64 v[122:123], v8 offset:22848
    ds_read_b64 v[124:125], v8 offset:23168
    ds_read_b64 v[10:11], v8 offset:23488
    s_waitcnt lgkmcnt(0)
    v_add_f32 v2, v120, v122
    v_add_f32 v3, v121, v123
    v_add_f32 v2, v2, v124
    v_add_f32 v3, v3, v125
    v_add_f32 v2, v2, v10
    v_add_f32 v3, v3, v11
    v_cvt_pk_bf16_f32 v2, v2, v3
    v_lshlrev_b32 v8, 2, v0
    s_mul_i32 s53, s49, 160
    buffer_store_dword v2, v8, s[36:39], s53 offen
    s_waitcnt vmcnt(0)
L_q_end:
    s_endpgm
L_krole:
    s_getpc_b64 s[62:63]
L_pc:
    s_sub_u32 s62, s62, L_pc-standalone__sliding_block_cached__decode_kernel
    s_subb_u32 s63, s63, 0
    v_lshlrev_b32 v4, 6, v0
    s_lshl_b32 s52, s51, 12
    v_add_u32 v4, s52, v4
    v_min_u32 v4, L_end-standalone__sliding_block_cached__decode_kernel, v4
    global_load_dword v5, v4, s[62:63]
    v_and_b32 v2, 15, v0
    v_lshrrev_b32 v3, 4, v0
    v_mul_u32_u24 v2, 384, v2
    v_lshlrev_b32 v10, 4, v3
    v_add_u32 v2, v2, v10
    s_lshl_b32 s53, s49, 7
    s_lshl_b32 s52, s51, 5
    s_add_u32 s53, s53, s52
    s_add_u32 s53, s53, 3072
    s_mul_i32 s53, s53, 384
    s_mul_i32 s52, s48, 1572864
    s_add_u32 s53, s53, s52
    s_barrier
    v_lshlrev_b32 v3, 4, v0
    buffer_load_dwordx4 v[16:19], v3, s[20:23], s53 offen offset:0 nt
    buffer_load_dwordx4 v[20:23], v3, s[20:23], s53 offen offset:1024 nt
    buffer_load_dwordx4 v[24:27], v3, s[20:23], s53 offen offset:2048 nt
    buffer_load_dwordx4 v[28:31], v3, s[20:23], s53 offen offset:3072 nt
    s_add_u32 s53, s53, 4096
    buffer_load_dwordx4 v[32:35], v3, s[20:23], s53 offen offset:0 nt
    buffer_load_dwordx4 v[36:39], v3, s[20:23], s53 offen offset:1024 nt
    buffer_load_dwordx4 v[40:43], v3, s[20:23], s53 offen offset:2048 nt
    buffer_load_dwordx4 v[44:47], v3, s[20:23], s53 offen offset:3072 nt
    s_add_u32 s53, s53, 4096
    s_waitcnt vmcnt(7)
    buffer_load_dwordx4 v[48:51], v3, s[20:23], s53 offen offset:0 nt
    s_waitcnt vmcnt(7)
    buffer_load_dwordx4 v[52:55], v3, s[20:23], s53 offen offset:1024 nt
    s_waitcnt vmcnt(7)
    buffer_load_dwordx4 v[56:59], v3, s[20:23], s53 offen offset:2048 nt
    s_waitcnt vmcnt(7)
    buffer_load_dwordx4 v[60:63], v3, s[20:23], s53 offen offset:3072 nt
    v_mov_b32 v126, 6688
    v_mov_b32 v127, 1
    s_mov_b64 s[68:69], exec
    s_mov_b64 exec, 1
    ds_add_u32 v126, v127
    s_mov_b64 exec, s[68:69]
    s_mul_i32 s52, s51, 12800
    s_add_u32 s52, s52, 24576
    v_add_u32 v4, 0, v0
    v_mul_u32_u24 v5, 2731, v4
    v_lshrrev_b32 v5, 16, v5
    v_add_u32 v4, v4, v5
    v_lshlrev_b32 v4, 4, v4
    v_add_u32 v4, s52, v4
    s_waitcnt vmcnt(11)
    ds_write_b128 v4, v[16:19]
    v_add_u32 v4, 64, v0
    v_mul_u32_u24 v5, 2731, v4
    v_lshrrev_b32 v5, 16, v5
    v_add_u32 v4, v4, v5
    v_lshlrev_b32 v4, 4, v4
    v_add_u32 v4, s52, v4
    s_waitcnt vmcnt(10)
    ds_write_b128 v4, v[20:23]
    v_add_u32 v4, 128, v0
    v_mul_u32_u24 v5, 2731, v4
    v_lshrrev_b32 v5, 16, v5
    v_add_u32 v4, v4, v5
    v_lshlrev_b32 v4, 4, v4
    v_add_u32 v4, s52, v4
    s_waitcnt vmcnt(9)
    ds_write_b128 v4, v[24:27]
    v_add_u32 v4, 192, v0
    v_mul_u32_u24 v5, 2731, v4
    v_lshrrev_b32 v5, 16, v5
    v_add_u32 v4, v4, v5
    v_lshlrev_b32 v4, 4, v4
    v_add_u32 v4, s52, v4
    s_waitcnt vmcnt(8)
    ds_write_b128 v4, v[28:31]
    v_add_u32 v4, 256, v0
    v_mul_u32_u24 v5, 2731, v4
    v_lshrrev_b32 v5, 16, v5
    v_add_u32 v4, v4, v5
    v_lshlrev_b32 v4, 4, v4
    v_add_u32 v4, s52, v4
    s_waitcnt vmcnt(7)
    ds_write_b128 v4, v[32:35]
    v_add_u32 v4, 320, v0
    v_mul_u32_u24 v5, 2731, v4
    v_lshrrev_b32 v5, 16, v5
    v_add_u32 v4, v4, v5
    v_lshlrev_b32 v4, 4, v4
    v_add_u32 v4, s52, v4
    s_waitcnt vmcnt(6)
    ds_write_b128 v4, v[36:39]
    v_add_u32 v4, 384, v0
    v_mul_u32_u24 v5, 2731, v4
    v_lshrrev_b32 v5, 16, v5
    v_add_u32 v4, v4, v5
    v_lshlrev_b32 v4, 4, v4
    v_add_u32 v4, s52, v4
    s_waitcnt vmcnt(5)
    ds_write_b128 v4, v[40:43]
    v_add_u32 v4, 448, v0
    v_mul_u32_u24 v5, 2731, v4
    v_lshrrev_b32 v5, 16, v5
    v_add_u32 v4, v4, v5
    v_lshlrev_b32 v4, 4, v4
    v_add_u32 v4, s52, v4
    s_waitcnt vmcnt(4)
    ds_write_b128 v4, v[44:47]
    v_add_u32 v4, 512, v0
    v_mul_u32_u24 v5, 2731, v4
    v_lshrrev_b32 v5, 16, v5
    v_add_u32 v4, v4, v5
    v_lshlrev_b32 v4, 4, v4
    v_add_u32 v4, s52, v4
    s_waitcnt vmcnt(3)
    ds_write_b128 v4, v[48:51]
    v_add_u32 v4, 576, v0
    v_mul_u32_u24 v5, 2731, v4
    v_lshrrev_b32 v5, 16, v5
    v_add_u32 v4, v4, v5
    v_lshlrev_b32 v4, 4, v4
    v_add_u32 v4, s52, v4
    s_waitcnt vmcnt(2)
    ds_write_b128 v4, v[52:55]
    v_add_u32 v4, 640, v0
    v_mul_u32_u24 v5, 2731, v4
    v_lshrrev_b32 v5, 16, v5
    v_add_u32 v4, v4, v5
    v_lshlrev_b32 v4, 4, v4
    v_add_u32 v4, s52, v4
    s_waitcnt vmcnt(1)
    ds_write_b128 v4, v[56:59]
    v_add_u32 v4, 704, v0
    v_mul_u32_u24 v5, 2731, v4
    v_lshrrev_b32 v5, 16, v5
    v_add_u32 v4, v4, v5
    v_lshlrev_b32 v4, 4, v4
    v_add_u32 v4, s52, v4
    s_waitcnt vmcnt(0)
    ds_write_b128 v4, v[60:63]
    v_and_b32 v4, 15, v0
    v_lshrrev_b32 v5, 4, v0
    v_mul_u32_u24 v4, 400, v4
    v_lshlrev_b32 v5, 4, v5
    v_add_u32 v4, v4, v5
    v_add_u32 v4, s52, v4
    s_waitcnt lgkmcnt(0)
    ds_read_b128 v[16:19], v4 offset:0
    ds_read_b128 v[20:23], v4 offset:64
    ds_read_b128 v[24:27], v4 offset:128
    ds_read_b128 v[28:31], v4 offset:192
    ds_read_b128 v[32:35], v4 offset:256
    ds_read_b128 v[36:39], v4 offset:320
    ds_read_b128 v[40:43], v4 offset:6400
    ds_read_b128 v[44:47], v4 offset:6464
    ds_read_b128 v[48:51], v4 offset:6528
    ds_read_b128 v[52:55], v4 offset:6592
    ds_read_b128 v[56:59], v4 offset:6656
    ds_read_b128 v[60:63], v4 offset:6720
    v_mov_b32 v126, 6696
    s_mov_b32 s69, 0
L_w5:
    ds_read_b32 v127, v126
    s_waitcnt lgkmcnt(0)
    v_readfirstlane_b32 s68, v127
    s_add_u32 s69, s69, 1
    s_cmp_ge_u32 s69, 1048576
    s_cbranch_scc1 L_w5d
    s_cmp_lt_u32 s68, 2
    s_cbranch_scc1 L_w5
L_w5d:
    v_lshrrev_b32 v3, 4, v0
    v_lshlrev_b32 v3, 4, v3
    ds_read_b128 v[64:67], v3 offset:6144
    ds_read_b128 v[68:71], v3 offset:6208
    ds_read_b128 v[72:75], v3 offset:6272
    ds_read_b128 v[76:79], v3 offset:6336
    ds_read_b128 v[80:83], v3 offset:6400
    ds_read_b128 v[84:87], v3 offset:6464
    s_waitcnt lgkmcnt(0)
    v_mfma_f32_16x16x32_bf16 v[8:11], v[16:19], v[64:67], 0
    v_mfma_f32_16x16x32_bf16 v[8:11], v[20:23], v[68:71], v[8:11]
    v_mfma_f32_16x16x32_bf16 v[8:11], v[24:27], v[72:75], v[8:11]
    v_mfma_f32_16x16x32_bf16 v[8:11], v[28:31], v[76:79], v[8:11]
    v_mfma_f32_16x16x32_bf16 v[8:11], v[32:35], v[80:83], v[8:11]
    v_mfma_f32_16x16x32_bf16 v[8:11], v[36:39], v[84:87], v[8:11]
    v_mfma_f32_16x16x32_bf16 v[12:15], v[40:43], v[64:67], 0
    v_mfma_f32_16x16x32_bf16 v[12:15], v[44:47], v[68:71], v[12:15]
    v_mfma_f32_16x16x32_bf16 v[12:15], v[48:51], v[72:75], v[12:15]
    v_mfma_f32_16x16x32_bf16 v[12:15], v[52:55], v[76:79], v[12:15]
    v_mfma_f32_16x16x32_bf16 v[12:15], v[56:59], v[80:83], v[12:15]
    v_mfma_f32_16x16x32_bf16 v[12:15], v[60:63], v[84:87], v[12:15]
    s_mov_b32 s56, 1033096506
    s_nop 7
    s_nop 3
    v_cvt_pk_bf16_f32 v2, v8, v9
    v_lshlrev_b32 v8, 16, v2
    v_and_b32 v9, 0xffff0000, v2
    v_mul_f32 v8, s56, v8
    v_mul_f32 v9, s56, v9
    v_cvt_pk_bf16_f32 v2, v8, v9
    v_lshlrev_b32 v8, 16, v2
    v_and_b32 v9, 0xffff0000, v2
    v_cvt_pk_bf16_f32 v2, v10, v11
    v_lshlrev_b32 v10, 16, v2
    v_and_b32 v11, 0xffff0000, v2
    v_mul_f32 v10, s56, v10
    v_mul_f32 v11, s56, v11
    v_cvt_pk_bf16_f32 v2, v10, v11
    v_lshlrev_b32 v10, 16, v2
    v_and_b32 v11, 0xffff0000, v2
    v_cvt_pk_bf16_f32 v2, v12, v13
    v_lshlrev_b32 v12, 16, v2
    v_and_b32 v13, 0xffff0000, v2
    v_mul_f32 v12, s56, v12
    v_mul_f32 v13, s56, v13
    v_cvt_pk_bf16_f32 v2, v12, v13
    v_lshlrev_b32 v12, 16, v2
    v_and_b32 v13, 0xffff0000, v2
    v_cvt_pk_bf16_f32 v2, v14, v15
    v_lshlrev_b32 v14, 16, v2
    v_and_b32 v15, 0xffff0000, v2
    v_mul_f32 v14, s56, v14
    v_mul_f32 v15, s56, v15
    v_cvt_pk_bf16_f32 v2, v14, v15
    v_lshlrev_b32 v14, 16, v2
    v_and_b32 v15, 0xffff0000, v2
    v_lshrrev_b32 v3, 4, v0
    v_lshlrev_b32 v3, 4, v3
    s_lshl_b32 s52, s51, 7
    v_add_u32 v3, s52, v3
    s_mov_b32 s66, 0x00010001
    s_mov_b32 s67, 0x00010001
    s_mov_b64 exec, s[66:67]
    ds_write_b128 v3, v[8:11] offset:6912
    ds_write_b128 v3, v[12:15] offset:6976
    s_mov_b64 exec, -1
    v_mov_b32 v126, 6700
    v_mov_b32 v127, 1
    s_mov_b64 s[68:69], exec
    s_mov_b64 exec, 1
    ds_add_u32 v126, v127
    s_mov_b64 exec, s[68:69]
    s_endpgm
L_wrole:
    s_barrier
    v_mov_b32 v126, 6720
    s_mov_b32 s69, 0
L_w6:
    ds_read_b32 v127, v126
    s_waitcnt lgkmcnt(0)
    v_readfirstlane_b32 s68, v127
    s_add_u32 s69, s69, 1
    s_cmp_ge_u32 s69, 1048576
    s_cbranch_scc1 L_w6d
    s_cmp_lt_u32 s68, 4
    s_cbranch_scc1 L_w6
L_w6d:
    v_mul_u32_u24 v2, 205, v0
    v_lshrrev_b32 v2, 11, v2
    v_mul_u32_u24 v3, 10, v2
    v_sub_u32 v3, v0, v3
    v_mul_u32_u24 v4, 1280, v2
    v_lshlrev_b32 v5, 4, v3
    v_add_u32 v4, v4, v5
    v_cmp_gt_u32 vcc, 60, v0
    v_mov_b32 v5, 0x7ffffff0
    s_nop 1
    v_cndmask_b32 v4, v5, v4, vcc
    s_mul_i32 s52, s48, 192
    s_mul_i32 s53, s51, 48
    s_add_u32 s52, s52, s53
    s_mul_i32 s52, s52, 1280
    s_mul_i32 s53, s49, 160
    s_add_u32 s52, s52, s53
    s_waitcnt vmcnt(7)
    buffer_load_dwordx4 v[88:91], v4, s[32:35], s52 offen nt
    s_add_u32 s52, s52, 7680
    s_waitcnt vmcnt(7)
    buffer_load_dwordx4 v[92:95], v4, s[32:35], s52 offen nt
    s_add_u32 s52, s52, 7680
    s_waitcnt vmcnt(7)
    buffer_load_dwordx4 v[96:99], v4, s[32:35], s52 offen nt
    s_add_u32 s52, s52, 7680
    s_waitcnt vmcnt(7)
    buffer_load_dwordx4 v[100:103], v4, s[32:35], s52 offen nt
    s_add_u32 s52, s52, 7680
    s_waitcnt vmcnt(7)
    buffer_load_dwordx4 v[104:107], v4, s[32:35], s52 offen nt
    s_add_u32 s52, s52, 7680
    s_waitcnt vmcnt(7)
    buffer_load_dwordx4 v[108:111], v4, s[32:35], s52 offen nt
    s_add_u32 s52, s52, 7680
    s_waitcnt vmcnt(7)
    buffer_load_dwordx4 v[112:115], v4, s[32:35], s52 offen nt
    s_add_u32 s52, s52, 7680
    s_waitcnt vmcnt(7)
    buffer_load_dwordx4 v[116:119], v4, s[32:35], s52 offen nt
    v_mov_b32 v126, 6708
    s_mov_b32 s69, 0
L_w7:
    ds_read_b32 v127, v126
    s_waitcnt lgkmcnt(0)
    v_readfirstlane_b32 s68, v127
    s_add_u32 s69, s69, 1
    s_cmp_ge_u32 s69, 1048576
    s_cbranch_scc1 L_w7d
    s_cmp_lt_u32 s68, 2
    s_cbranch_scc1 L_w7
L_w7d:
    v_mul_u32_u24 v2, 205, v0
    v_lshrrev_b32 v2, 11, v2
    v_mul_u32_u24 v3, 10, v2
    v_sub_u32 v3, v0, v3
    v_lshlrev_b32 v4, 2, v2
    s_mul_i32 s52, s51, 192
    v_add_u32 v4, s52, v4
    ds_read_b32 v16, v4 offset:7680
    ds_read_b32 v17, v4 offset:7704
    ds_read_b32 v18, v4 offset:7728
    ds_read_b32 v19, v4 offset:7752
    ds_read_b32 v20, v4 offset:7776
    ds_read_b32 v21, v4 offset:7800
    ds_read_b32 v22, v4 offset:7824
    ds_read_b32 v23, v4 offset:7848
    v_mov_b32 v24, 0
    v_mov_b32 v25, 0
    v_mov_b32 v26, 0
    v_mov_b32 v27, 0
    v_mov_b32 v28, 0
    v_mov_b32 v29, 0
    v_mov_b32 v30, 0
    v_mov_b32 v31, 0
    s_waitcnt vmcnt(0) lgkmcnt(0)
    v_lshlrev_b32 v10, 16, v88
    v_and_b32 v11, 0xffff0000, v88
    v_fmac_f32 v24, v16, v10
    v_fmac_f32 v25, v16, v11
    v_lshlrev_b32 v10, 16, v89
    v_and_b32 v11, 0xffff0000, v89
    v_fmac_f32 v26, v16, v10
    v_fmac_f32 v27, v16, v11
    v_lshlrev_b32 v10, 16, v90
    v_and_b32 v11, 0xffff0000, v90
    v_fmac_f32 v28, v16, v10
    v_fmac_f32 v29, v16, v11
    v_lshlrev_b32 v10, 16, v91
    v_and_b32 v11, 0xffff0000, v91
    v_fmac_f32 v30, v16, v10
    v_fmac_f32 v31, v16, v11
    v_lshlrev_b32 v10, 16, v92
    v_and_b32 v11, 0xffff0000, v92
    v_fmac_f32 v24, v17, v10
    v_fmac_f32 v25, v17, v11
    v_lshlrev_b32 v10, 16, v93
    v_and_b32 v11, 0xffff0000, v93
    v_fmac_f32 v26, v17, v10
    v_fmac_f32 v27, v17, v11
    v_lshlrev_b32 v10, 16, v94
    v_and_b32 v11, 0xffff0000, v94
    v_fmac_f32 v28, v17, v10
    v_fmac_f32 v29, v17, v11
    v_lshlrev_b32 v10, 16, v95
    v_and_b32 v11, 0xffff0000, v95
    v_fmac_f32 v30, v17, v10
    v_fmac_f32 v31, v17, v11
    v_lshlrev_b32 v10, 16, v96
    v_and_b32 v11, 0xffff0000, v96
    v_fmac_f32 v24, v18, v10
    v_fmac_f32 v25, v18, v11
    v_lshlrev_b32 v10, 16, v97
    v_and_b32 v11, 0xffff0000, v97
    v_fmac_f32 v26, v18, v10
    v_fmac_f32 v27, v18, v11
    v_lshlrev_b32 v10, 16, v98
    v_and_b32 v11, 0xffff0000, v98
    v_fmac_f32 v28, v18, v10
    v_fmac_f32 v29, v18, v11
    v_lshlrev_b32 v10, 16, v99
    v_and_b32 v11, 0xffff0000, v99
    v_fmac_f32 v30, v18, v10
    v_fmac_f32 v31, v18, v11
    v_lshlrev_b32 v10, 16, v100
    v_and_b32 v11, 0xffff0000, v100
    v_fmac_f32 v24, v19, v10
    v_fmac_f32 v25, v19, v11
    v_lshlrev_b32 v10, 16, v101
    v_and_b32 v11, 0xffff0000, v101
    v_fmac_f32 v26, v19, v10
    v_fmac_f32 v27, v19, v11
    v_lshlrev_b32 v10, 16, v102
    v_and_b32 v11, 0xffff0000, v102
    v_fmac_f32 v28, v19, v10
    v_fmac_f32 v29, v19, v11
    v_lshlrev_b32 v10, 16, v103
    v_and_b32 v11, 0xffff0000, v103
    v_fmac_f32 v30, v19, v10
    v_fmac_f32 v31, v19, v11
    v_lshlrev_b32 v10, 16, v104
    v_and_b32 v11, 0xffff0000, v104
    v_fmac_f32 v24, v20, v10
    v_fmac_f32 v25, v20, v11
    v_lshlrev_b32 v10, 16, v105
    v_and_b32 v11, 0xffff0000, v105
    v_fmac_f32 v26, v20, v10
    v_fmac_f32 v27, v20, v11
    v_lshlrev_b32 v10, 16, v106
    v_and_b32 v11, 0xffff0000, v106
    v_fmac_f32 v28, v20, v10
    v_fmac_f32 v29, v20, v11
    v_lshlrev_b32 v10, 16, v107
    v_and_b32 v11, 0xffff0000, v107
    v_fmac_f32 v30, v20, v10
    v_fmac_f32 v31, v20, v11
    v_lshlrev_b32 v10, 16, v108
    v_and_b32 v11, 0xffff0000, v108
    v_fmac_f32 v24, v21, v10
    v_fmac_f32 v25, v21, v11
    v_lshlrev_b32 v10, 16, v109
    v_and_b32 v11, 0xffff0000, v109
    v_fmac_f32 v26, v21, v10
    v_fmac_f32 v27, v21, v11
    v_lshlrev_b32 v10, 16, v110
    v_and_b32 v11, 0xffff0000, v110
    v_fmac_f32 v28, v21, v10
    v_fmac_f32 v29, v21, v11
    v_lshlrev_b32 v10, 16, v111
    v_and_b32 v11, 0xffff0000, v111
    v_fmac_f32 v30, v21, v10
    v_fmac_f32 v31, v21, v11
    v_lshlrev_b32 v10, 16, v112
    v_and_b32 v11, 0xffff0000, v112
    v_fmac_f32 v24, v22, v10
    v_fmac_f32 v25, v22, v11
    v_lshlrev_b32 v10, 16, v113
    v_and_b32 v11, 0xffff0000, v113
    v_fmac_f32 v26, v22, v10
    v_fmac_f32 v27, v22, v11
    v_lshlrev_b32 v10, 16, v114
    v_and_b32 v11, 0xffff0000, v114
    v_fmac_f32 v28, v22, v10
    v_fmac_f32 v29, v22, v11
    v_lshlrev_b32 v10, 16, v115
    v_and_b32 v11, 0xffff0000, v115
    v_fmac_f32 v30, v22, v10
    v_fmac_f32 v31, v22, v11
    v_lshlrev_b32 v10, 16, v116
    v_and_b32 v11, 0xffff0000, v116
    v_fmac_f32 v24, v23, v10
    v_fmac_f32 v25, v23, v11
    v_lshlrev_b32 v10, 16, v117
    v_and_b32 v11, 0xffff0000, v117
    v_fmac_f32 v26, v23, v10
    v_fmac_f32 v27, v23, v11
    v_lshlrev_b32 v10, 16, v118
    v_and_b32 v11, 0xffff0000, v118
    v_fmac_f32 v28, v23, v10
    v_fmac_f32 v29, v23, v11
    v_lshlrev_b32 v10, 16, v119
    v_and_b32 v11, 0xffff0000, v119
    v_fmac_f32 v30, v23, v10
    v_fmac_f32 v31, v23, v11
    v_mul_u32_u24 v4, 320, v2
    v_lshlrev_b32 v5, 5, v3
    v_add_u32 v4, v4, v5
    s_mul_i32 s52, s51, 1920
    v_add_u32 v4, s52, v4
    s_mov_b32 s66, -1
    s_mov_b32 s67, 0x0fffffff
    s_mov_b64 exec, s[66:67]
    ds_write_b128 v4, v[24:27] offset:14848
    ds_write_b128 v4, v[28:31] offset:14864
    s_mov_b64 exec, -1
    v_mov_b32 v126, 6712
    v_mov_b32 v127, 1
    s_mov_b64 s[68:69], exec
    s_mov_b64 exec, 1
    ds_add_u32 v126, v127
    s_mov_b64 exec, s[68:69]
    s_endpgm
L_vrole:
    s_barrier
    v_mov_b32 v126, 6688
    s_mov_b32 s69, 0
L_w8:
    ds_read_b32 v127, v126
    s_waitcnt lgkmcnt(0)
    v_readfirstlane_b32 s68, v127
    s_add_u32 s69, s69, 1
    s_cmp_ge_u32 s69, 1048576
    s_cbranch_scc1 L_w8d
    s_cmp_lt_u32 s68, 4
    s_cbranch_scc1 L_w8
L_w8d:
    v_mul_u32_u24 v1, 12, v0
    s_lshl_b32 s53, s49, 7
    s_lshl_b32 s52, s51, 5
    s_add_u32 s53, s53, s52
    s_add_u32 s53, s53, 3072
    s_mul_i32 s53, s53, 384
    s_mul_i32 s52, s48, 1572864
    s_add_u32 s53, s53, s52
    buffer_load_dwordx3 v[16:18], v1, s[24:27], s53 offen offset:0 nt
    buffer_load_dwordx3 v[20:22], v1, s[24:27], s53 offen offset:768 nt
    buffer_load_dwordx3 v[24:26], v1, s[24:27], s53 offen offset:1536 nt
    buffer_load_dwordx3 v[28:30], v1, s[24:27], s53 offen offset:2304 nt
    s_add_u32 s53, s53, 3072
    buffer_load_dwordx3 v[32:34], v1, s[24:27], s53 offen offset:0 nt
    buffer_load_dwordx3 v[36:38], v1, s[24:27], s53 offen offset:768 nt
    buffer_load_dwordx3 v[40:42], v1, s[24:27], s53 offen offset:1536 nt
    buffer_load_dwordx3 v[44:46], v1, s[24:27], s53 offen offset:2304 nt
    s_add_u32 s53, s53, 3072
    s_waitcnt vmcnt(7)
    buffer_load_dwordx3 v[48:50], v1, s[24:27], s53 offen offset:0 nt
    s_waitcnt vmcnt(7)
    buffer_load_dwordx3 v[52:54], v1, s[24:27], s53 offen offset:768 nt
    s_waitcnt vmcnt(7)
    buffer_load_dwordx3 v[56:58], v1, s[24:27], s53 offen offset:1536 nt
    s_waitcnt vmcnt(7)
    buffer_load_dwordx3 v[60:62], v1, s[24:27], s53 offen offset:2304 nt
    s_add_u32 s53, s53, 3072
    s_waitcnt vmcnt(7)
    buffer_load_dwordx3 v[64:66], v1, s[24:27], s53 offen offset:0 nt
    s_waitcnt vmcnt(7)
    buffer_load_dwordx3 v[68:70], v1, s[24:27], s53 offen offset:768 nt
    s_waitcnt vmcnt(7)
    buffer_load_dwordx3 v[72:74], v1, s[24:27], s53 offen offset:1536 nt
    s_waitcnt vmcnt(7)
    buffer_load_dwordx3 v[76:78], v1, s[24:27], s53 offen offset:2304 nt
    v_mov_b32 v126, 6720
    v_mov_b32 v127, 1
    s_mov_b64 s[68:69], exec
    s_mov_b64 exec, 1
    ds_add_u32 v126, v127
    s_mov_b64 exec, s[68:69]
    v_mov_b32 v126, 6700
    s_mov_b32 s69, 0
L_w9:
    ds_read_b32 v127, v126
    s_waitcnt lgkmcnt(0)
    v_readfirstlane_b32 s68, v127
    s_add_u32 s69, s69, 1
    s_cmp_ge_u32 s69, 1048576
    s_cbranch_scc1 L_w9d
    s_cmp_lt_u32 s68, 4
    s_cbranch_scc1 L_w9
L_w9d:
    v_lshlrev_b32 v8, 3, v0
    ds_read_b64 v[8:9], v8 offset:6912
    v_lshrrev_b32 v10, 5, v0
    v_lshlrev_b32 v10, 2, v10
    s_lshl_b32 s52, s51, 7
    v_add_u32 v10, s52, v10
    ds_read_b32 v112, v10 offset:6912
    ds_read_b32 v113, v10 offset:6920
    ds_read_b32 v114, v10 offset:6928
    ds_read_b32 v115, v10 offset:6936
    ds_read_b32 v116, v10 offset:6944
    ds_read_b32 v117, v10 offset:6952
    ds_read_b32 v118, v10 offset:6960
    ds_read_b32 v119, v10 offset:6968
    ds_read_b32 v120, v10 offset:6976
    ds_read_b32 v121, v10 offset:6984
    ds_read_b32 v122, v10 offset:6992
    ds_read_b32 v123, v10 offset:7000
    ds_read_b32 v124, v10 offset:7008
    ds_read_b32 v125, v10 offset:7016
    ds_read_b32 v126, v10 offset:7024
    ds_read_b32 v127, v10 offset:7032
    s_waitcnt lgkmcnt(0)
    v_max_f32 v8, v8, v9
    s_nop 1
    v_max_f32_dpp v8, v8, v8 row_shr:1 row_mask:0xf bank_mask:0xf
    s_nop 1
    v_max_f32_dpp v8, v8, v8 row_shr:2 row_mask:0xf bank_mask:0xf
    s_nop 1
    v_max_f32_dpp v8, v8, v8 row_shr:4 row_mask:0xf bank_mask:0xf
    s_nop 1
    v_max_f32_dpp v8, v8, v8 row_shr:8 row_mask:0xf bank_mask:0xf
    s_nop 1
    v_max_f32_dpp v8, v8, v8 row_bcast:15 row_mask:0xa bank_mask:0xf
    s_nop 1
    v_max_f32_dpp v8, v8, v8 row_bcast:31 row_mask:0xc bank_mask:0xf
    s_nop 1
    v_readlane_b32 s57, v8, 63
    s_mov_b32 s58, 1069066811
    s_nop 1
    v_mov_b32 v9, 0
    v_subrev_f32 v112, s57, v112
    v_mul_f32 v112, s58, v112
    v_exp_f32 v112, v112
    v_subrev_f32 v113, s57, v113
    v_mul_f32 v113, s58, v113
    v_exp_f32 v113, v113
    v_subrev_f32 v114, s57, v114
    v_mul_f32 v114, s58, v114
    v_exp_f32 v114, v114
    v_subrev_f32 v115, s57, v115
    v_mul_f32 v115, s58, v115
    v_exp_f32 v115, v115
    v_subrev_f32 v116, s57, v116
    v_mul_f32 v116, s58, v116
    v_exp_f32 v116, v116
    v_subrev_f32 v117, s57, v117
    v_mul_f32 v117, s58, v117
    v_exp_f32 v117, v117
    v_subrev_f32 v118, s57, v118
    v_mul_f32 v118, s58, v118
    v_exp_f32 v118, v118
    v_subrev_f32 v119, s57, v119
    v_mul_f32 v119, s58, v119
    v_exp_f32 v119, v119
    v_subrev_f32 v120, s57, v120
    v_mul_f32 v120, s58, v120
    v_exp_f32 v120, v120
    v_subrev_f32 v121, s57, v121
    v_mul_f32 v121, s58, v121
    v_exp_f32 v121, v121
    v_subrev_f32 v122, s57, v122
    v_mul_f32 v122, s58, v122
    v_exp_f32 v122, v122
    v_subrev_f32 v123, s57, v123
    v_mul_f32 v123, s58, v123
    v_exp_f32 v123, v123
    v_subrev_f32 v124, s57, v124
    v_mul_f32 v124, s58, v124
    v_exp_f32 v124, v124
    v_subrev_f32 v125, s57, v125
    v_mul_f32 v125, s58, v125
    v_exp_f32 v125, v125
    v_subrev_f32 v126, s57, v126
    v_mul_f32 v126, s58, v126
    v_exp_f32 v126, v126
    v_subrev_f32 v127, s57, v127
    v_mul_f32 v127, s58, v127
    v_exp_f32 v127, v127
    s_nop 0
    v_add_f32 v9, v9, v112
    v_add_f32 v9, v9, v113
    v_add_f32 v9, v9, v114
    v_add_f32 v9, v9, v115
    v_add_f32 v9, v9, v116
    v_add_f32 v9, v9, v117
    v_add_f32 v9, v9, v118
    v_add_f32 v9, v9, v119
    v_add_f32 v9, v9, v120
    v_add_f32 v9, v9, v121
    v_add_f32 v9, v9, v122
    v_add_f32 v9, v9, v123
    v_add_f32 v9, v9, v124
    v_add_f32 v9, v9, v125
    v_add_f32 v9, v9, v126
    v_add_f32 v9, v9, v127
    v_mov_b32 v2, 0
    v_mov_b32 v3, 0
    v_mov_b32 v4, 0
    v_mov_b32 v5, 0
    v_mov_b32 v6, 0
    v_mov_b32 v7, 0
    s_waitcnt vmcnt(15)
    v_lshlrev_b32 v10, 16, v16
    v_and_b32 v11, 0xffff0000, v16
    v_fmac_f32 v2, v112, v10
    v_fmac_f32 v3, v112, v11
    v_lshlrev_b32 v10, 16, v17
    v_and_b32 v11, 0xffff0000, v17
    v_fmac_f32 v4, v112, v10
    v_fmac_f32 v5, v112, v11
    v_lshlrev_b32 v10, 16, v18
    v_and_b32 v11, 0xffff0000, v18
    v_fmac_f32 v6, v112, v10
    v_fmac_f32 v7, v112, v11
    s_waitcnt vmcnt(14)
    v_lshlrev_b32 v10, 16, v20
    v_and_b32 v11, 0xffff0000, v20
    v_fmac_f32 v2, v113, v10
    v_fmac_f32 v3, v113, v11
    v_lshlrev_b32 v10, 16, v21
    v_and_b32 v11, 0xffff0000, v21
    v_fmac_f32 v4, v113, v10
    v_fmac_f32 v5, v113, v11
    v_lshlrev_b32 v10, 16, v22
    v_and_b32 v11, 0xffff0000, v22
    v_fmac_f32 v6, v113, v10
    v_fmac_f32 v7, v113, v11
    s_waitcnt vmcnt(13)
    v_lshlrev_b32 v10, 16, v24
    v_and_b32 v11, 0xffff0000, v24
    v_fmac_f32 v2, v114, v10
    v_fmac_f32 v3, v114, v11
    v_lshlrev_b32 v10, 16, v25
    v_and_b32 v11, 0xffff0000, v25
    v_fmac_f32 v4, v114, v10
    v_fmac_f32 v5, v114, v11
    v_lshlrev_b32 v10, 16, v26
    v_and_b32 v11, 0xffff0000, v26
    v_fmac_f32 v6, v114, v10
    v_fmac_f32 v7, v114, v11
    s_waitcnt vmcnt(12)
    v_lshlrev_b32 v10, 16, v28
    v_and_b32 v11, 0xffff0000, v28
    v_fmac_f32 v2, v115, v10
    v_fmac_f32 v3, v115, v11
    v_lshlrev_b32 v10, 16, v29
    v_and_b32 v11, 0xffff0000, v29
    v_fmac_f32 v4, v115, v10
    v_fmac_f32 v5, v115, v11
    v_lshlrev_b32 v10, 16, v30
    v_and_b32 v11, 0xffff0000, v30
    v_fmac_f32 v6, v115, v10
    v_fmac_f32 v7, v115, v11
    s_waitcnt vmcnt(11)
    v_lshlrev_b32 v10, 16, v32
    v_and_b32 v11, 0xffff0000, v32
    v_fmac_f32 v2, v116, v10
    v_fmac_f32 v3, v116, v11
    v_lshlrev_b32 v10, 16, v33
    v_and_b32 v11, 0xffff0000, v33
    v_fmac_f32 v4, v116, v10
    v_fmac_f32 v5, v116, v11
    v_lshlrev_b32 v10, 16, v34
    v_and_b32 v11, 0xffff0000, v34
    v_fmac_f32 v6, v116, v10
    v_fmac_f32 v7, v116, v11
    s_waitcnt vmcnt(10)
    v_lshlrev_b32 v10, 16, v36
    v_and_b32 v11, 0xffff0000, v36
    v_fmac_f32 v2, v117, v10
    v_fmac_f32 v3, v117, v11
    v_lshlrev_b32 v10, 16, v37
    v_and_b32 v11, 0xffff0000, v37
    v_fmac_f32 v4, v117, v10
    v_fmac_f32 v5, v117, v11
    v_lshlrev_b32 v10, 16, v38
    v_and_b32 v11, 0xffff0000, v38
    v_fmac_f32 v6, v117, v10
    v_fmac_f32 v7, v117, v11
    s_waitcnt vmcnt(9)
    v_lshlrev_b32 v10, 16, v40
    v_and_b32 v11, 0xffff0000, v40
    v_fmac_f32 v2, v118, v10
    v_fmac_f32 v3, v118, v11
    v_lshlrev_b32 v10, 16, v41
    v_and_b32 v11, 0xffff0000, v41
    v_fmac_f32 v4, v118, v10
    v_fmac_f32 v5, v118, v11
    v_lshlrev_b32 v10, 16, v42
    v_and_b32 v11, 0xffff0000, v42
    v_fmac_f32 v6, v118, v10
    v_fmac_f32 v7, v118, v11
    s_waitcnt vmcnt(8)
    v_lshlrev_b32 v10, 16, v44
    v_and_b32 v11, 0xffff0000, v44
    v_fmac_f32 v2, v119, v10
    v_fmac_f32 v3, v119, v11
    v_lshlrev_b32 v10, 16, v45
    v_and_b32 v11, 0xffff0000, v45
    v_fmac_f32 v4, v119, v10
    v_fmac_f32 v5, v119, v11
    v_lshlrev_b32 v10, 16, v46
    v_and_b32 v11, 0xffff0000, v46
    v_fmac_f32 v6, v119, v10
    v_fmac_f32 v7, v119, v11
    s_waitcnt vmcnt(7)
    v_lshlrev_b32 v10, 16, v48
    v_and_b32 v11, 0xffff0000, v48
    v_fmac_f32 v2, v120, v10
    v_fmac_f32 v3, v120, v11
    v_lshlrev_b32 v10, 16, v49
    v_and_b32 v11, 0xffff0000, v49
    v_fmac_f32 v4, v120, v10
    v_fmac_f32 v5, v120, v11
    v_lshlrev_b32 v10, 16, v50
    v_and_b32 v11, 0xffff0000, v50
    v_fmac_f32 v6, v120, v10
    v_fmac_f32 v7, v120, v11
    s_waitcnt vmcnt(6)
    v_lshlrev_b32 v10, 16, v52
    v_and_b32 v11, 0xffff0000, v52
    v_fmac_f32 v2, v121, v10
    v_fmac_f32 v3, v121, v11
    v_lshlrev_b32 v10, 16, v53
    v_and_b32 v11, 0xffff0000, v53
    v_fmac_f32 v4, v121, v10
    v_fmac_f32 v5, v121, v11
    v_lshlrev_b32 v10, 16, v54
    v_and_b32 v11, 0xffff0000, v54
    v_fmac_f32 v6, v121, v10
    v_fmac_f32 v7, v121, v11
    s_waitcnt vmcnt(5)
    v_lshlrev_b32 v10, 16, v56
    v_and_b32 v11, 0xffff0000, v56
    v_fmac_f32 v2, v122, v10
    v_fmac_f32 v3, v122, v11
    v_lshlrev_b32 v10, 16, v57
    v_and_b32 v11, 0xffff0000, v57
    v_fmac_f32 v4, v122, v10
    v_fmac_f32 v5, v122, v11
    v_lshlrev_b32 v10, 16, v58
    v_and_b32 v11, 0xffff0000, v58
    v_fmac_f32 v6, v122, v10
    v_fmac_f32 v7, v122, v11
    s_waitcnt vmcnt(4)
    v_lshlrev_b32 v10, 16, v60
    v_and_b32 v11, 0xffff0000, v60
    v_fmac_f32 v2, v123, v10
    v_fmac_f32 v3, v123, v11
    v_lshlrev_b32 v10, 16, v61
    v_and_b32 v11, 0xffff0000, v61
    v_fmac_f32 v4, v123, v10
    v_fmac_f32 v5, v123, v11
    v_lshlrev_b32 v10, 16, v62
    v_and_b32 v11, 0xffff0000, v62
    v_fmac_f32 v6, v123, v10
    v_fmac_f32 v7, v123, v11
    s_waitcnt vmcnt(3)
    v_lshlrev_b32 v10, 16, v64
    v_and_b32 v11, 0xffff0000, v64
    v_fmac_f32 v2, v124, v10
    v_fmac_f32 v3, v124, v11
    v_lshlrev_b32 v10, 16, v65
    v_and_b32 v11, 0xffff0000, v65
    v_fmac_f32 v4, v124, v10
    v_fmac_f32 v5, v124, v11
    v_lshlrev_b32 v10, 16, v66
    v_and_b32 v11, 0xffff0000, v66
    v_fmac_f32 v6, v124, v10
    v_fmac_f32 v7, v124, v11
    s_waitcnt vmcnt(2)
    v_lshlrev_b32 v10, 16, v68
    v_and_b32 v11, 0xffff0000, v68
    v_fmac_f32 v2, v125, v10
    v_fmac_f32 v3, v125, v11
    v_lshlrev_b32 v10, 16, v69
    v_and_b32 v11, 0xffff0000, v69
    v_fmac_f32 v4, v125, v10
    v_fmac_f32 v5, v125, v11
    v_lshlrev_b32 v10, 16, v70
    v_and_b32 v11, 0xffff0000, v70
    v_fmac_f32 v6, v125, v10
    v_fmac_f32 v7, v125, v11
    s_waitcnt vmcnt(1)
    v_lshlrev_b32 v10, 16, v72
    v_and_b32 v11, 0xffff0000, v72
    v_fmac_f32 v2, v126, v10
    v_fmac_f32 v3, v126, v11
    v_lshlrev_b32 v10, 16, v73
    v_and_b32 v11, 0xffff0000, v73
    v_fmac_f32 v4, v126, v10
    v_fmac_f32 v5, v126, v11
    v_lshlrev_b32 v10, 16, v74
    v_and_b32 v11, 0xffff0000, v74
    v_fmac_f32 v6, v126, v10
    v_fmac_f32 v7, v126, v11
    s_waitcnt vmcnt(0)
    v_lshlrev_b32 v10, 16, v76
    v_and_b32 v11, 0xffff0000, v76
    v_fmac_f32 v2, v127, v10
    v_fmac_f32 v3, v127, v11
    v_lshlrev_b32 v10, 16, v77
    v_and_b32 v11, 0xffff0000, v77
    v_fmac_f32 v4, v127, v10
    v_fmac_f32 v5, v127, v11
    v_lshlrev_b32 v10, 16, v78
    v_and_b32 v11, 0xffff0000, v78
    v_fmac_f32 v6, v127, v10
    v_fmac_f32 v7, v127, v11
    v_and_b32 v1, 31, v0
    v_lshrrev_b32 v10, 5, v0
    v_mul_u32_u24 v1, 24, v1
    v_mul_u32_u24 v11, 768, v10
    v_add_u32 v1, v1, v11
    s_mul_i32 s52, s51, 1536
    v_add_u32 v1, s52, v1
    ds_write_b64 v1, v[2:3] offset:8704
    ds_write_b64 v1, v[4:5] offset:8712
    ds_write_b64 v1, v[6:7] offset:8720
    v_lshlrev_b32 v10, 2, v10
    s_lshl_b32 s52, s51, 3
    v_add_u32 v10, s52, v10
    v_mov_b32 v11, s57
    v_mov_b32 v12, 7456
    s_mov_b32 s66, 1
    s_mov_b32 s67, 1
    s_mov_b64 exec, s[66:67]
    ds_write_b32 v10, v9 offset:7424
    ds_write_b32 v12, v11
    s_mov_b64 exec, -1
    v_mov_b32 v126, 6704
    v_mov_b32 v127, 1
    s_mov_b64 s[68:69], exec
    s_mov_b64 exec, 1
    ds_add_u32 v126, v127
    s_mov_b64 exec, s[68:69]
L_end:
    s_endpgm
.section .rodata,"a"
.p2align 6
.amdhsa_kernel standalone__sliding_block_cached__decode_kernel
  .amdhsa_next_free_vgpr 128
  .amdhsa_next_free_sgpr 96
  .amdhsa_accum_offset 128
  .amdhsa_group_segment_fixed_size 0
  .amdhsa_kernarg_size 64
  .amdhsa_user_sgpr_count 2
  .amdhsa_user_sgpr_kernarg_segment_ptr 1
  .amdhsa_system_sgpr_workgroup_id_x 1
  .amdhsa_float_denorm_mode_32 3
.end_amdhsa_kernel
```
